```python
import torch

def _softmax(x, axis=-1):
    return torch.softmax(x, dim=axis)

def _gelu(x):
    return torch.nn.functional.gelu(x, approximate='tanh')

def _silu(x):
    return torch.nn.functional.silu(x)

def _sigmoid(x):
    return torch.sigmoid(x)

def _layernorm(x, axis=-1, eps=1e-05):
    m = x.mean(dim=axis, keepdim=True)
    v = x.var(dim=axis, keepdim=True, unbiased=False)
    return (x - m) / torch.sqrt(v + eps)

def _scatter_add(tgt, idx, src, axis=0):
    return tgt.clone().index_add_(axis, idx, src)

def _segment_sum(src, seg, n):
    out = torch.zeros((n,) + src.shape[1:], dtype=src.dtype)
    return out.index_add_(0, seg, src)

def _pad(x, pw):
    flat = tuple((v for pair in reversed(pw) for v in pair))
    return torch.nn.functional.pad(x, flat)
kernel_name = 'gather_scatter__tensor_product_equiv_equiformer__graph'

def setup_inputs():

    _w = lambda a: (lambda t: t.to(torch.bfloat16) if t.is_floating_point() else t)(torch.as_tensor(a))
    N, deg, C, De = (10000, 16, 128, max(0, 1))
    E = N * deg
    src = (lambda lo, hi, *s: torch.randint(lo, hi, s))(0, N, E).to(torch.int64)
    dst = (lambda lo, hi, *s: torch.randint(lo, hi, s))(0, N, E).to(torch.int64)
    rvec = (lambda *s: torch.randn(*s, dtype=torch.bfloat16) * 0.05)(E, 3).to(float)
    rn = (torch.linalg.norm(rvec, dim=-1, keepdim=True) + 1e-06).to(float)
    rhat = (rvec / rn).to(float)
    eps = torch.zeros((3, 3, 3), dtype=float)
    eps[0, 1, 2] = eps[1, 2, 0] = eps[2, 0, 1] = 1.0
    eps[0, 2, 1] = eps[2, 1, 0] = eps[1, 0, 2] = -1.0
    return {'x': _w((lambda *s: torch.randn(*s, dtype=torch.bfloat16) * 0.4)(N, 4 * C).to(float)), 'rhat': _w(rhat), 'e_attr': _w((lambda *s: torch.randn(*s, dtype=torch.bfloat16) * 0.4)(E, De).to(float)), 'src': _w(src), 'dst': _w(dst), 'w_rad': _w((lambda *s: torch.randn(*s, dtype=torch.bfloat16) * 0.4)(De, 5 * C).to(float)), 'w_si0': _w((lambda *s: torch.randn(*s, dtype=torch.bfloat16) * 0.4)(2 * C, C).to(float)), 'w_si1': _w((lambda *s: torch.randn(*s, dtype=torch.bfloat16) * 0.05)(3 * C, C).to(float)), 'cg_eps': _w(eps)}

def reference(x, rhat, e_attr, src, dst, w_rad, w_si0, w_si1, cg_eps):
    N = x.shape[0]
    C = w_si0.shape[1]
    E = rhat.shape[0]
    x0 = x[:, :C].clone()
    x1 = x[:, C:].reshape(N, 3, C)
    R = (e_attr @ w_rad).reshape(E, 5, C)
    f0 = x0[src]
    f1 = x1[src]
    Y1 = rhat
    p00_0 = f0 * R[:, 0, :]
    p11_0 = torch.einsum('ejc,ej->ec', f1, Y1) * R[:, 1, :]
    p01_1 = torch.einsum('ec,ej->ejc', f0, Y1) * R[:, 2, :][:, None, :]
    p10_1 = f1 * R[:, 3, :][:, None, :]
    p11_1 = torch.einsum('ijk,ekc,ej->eic', cg_eps, f1, Y1) * R[:, 4, :][:, None, :]
    m0 = torch.concatenate([p00_0, p11_0], axis=-1) @ w_si0
    m1 = torch.einsum('ejp,pc->ejc', torch.concatenate([p01_1, p10_1, p11_1], axis=-1), w_si1)
    agg0 = _segment_sum(m0, dst, N)
    agg1 = _segment_sum(m1.reshape(E, 3 * C), dst, N).reshape(N, 3, C)
    gate = _sigmoid(agg0)
    out1 = agg1 * gate[:, None, :]
    return torch.concatenate([agg0, out1.reshape(N, 3 * C)], axis=-1)
```

```asm
; @launch kernel=gs_prep_kernel grid=(272,1,1) block=(640,1,1) lds=31744
; @launch kernel=gather_scatter__tensor_product_equiv_equiformer__graph_kernel grid=(256,1,1) block=(1024,1,1) lds=146240
.amdgcn_target "amdgcn-amd-amdhsa--gfx950"
.text
.globl gs_prep_kernel
.p2align 8
.type gs_prep_kernel,@function
gs_prep_kernel:
    s_cmp_ge_u32 s2, 272
    s_cbranch_scc1 P_END
    s_load_dwordx2 s[6:7], s[0:1], 88
    s_cmp_lt_u32 s2, 16
    s_cbranch_scc1 P_WEIGHTS
    s_sub_u32 s2, s2, 16
    s_load_dwordx8 s[8:15], s[0:1], 8
    v_lshlrev_b32 v1, 4, v0
    v_mul_u32_u24 v2, 24, v0
    v_lshlrev_b32 v3, 3, v0
    v_lshlrev_b32 v4, 2, v0
    v_mov_b32 v5, 0
    v_mov_b32 v6, 1
    s_and_b32 s47, s2, 63
    s_lshr_b32 s48, s2, 6
    s_lshl_b32 s49, s48, 6
    s_mul_i32 s36, s47, 10000
    s_mul_i32 s37, s47, 15000
    s_mul_i32 s38, s47, 5000
    s_mov_b32 s39, 6871948
    s_waitcnt lgkmcnt(0)
    s_mov_b32 s16, s8
    s_mov_b32 s17, s9
    s_mov_b32 s18, 0xea600
    s_mov_b32 s19, 0x20000
    s_mov_b32 s20, s10
    s_mov_b32 s21, s11
    s_mov_b32 s22, 0x4e200
    s_mov_b32 s23, 0x20000
    s_mov_b32 s24, s12
    s_mov_b32 s25, s13
    s_mov_b32 s26, 0x9c400
    s_mov_b32 s27, 0x20000
    s_mov_b32 s28, s14
    s_mov_b32 s29, s15
    s_mov_b32 s30, 0x9c400
    s_mov_b32 s31, 0x20000
    s_mov_b32 s32, s6
    s_mov_b32 s33, s7
    s_mov_b32 s34, 0xe00000
    s_mov_b32 s35, 0x20000
    v_cmp_gt_u32 vcc, 625, v0
    s_and_saveexec_b64 s[40:41], vcc
    s_cbranch_execz P_NOLOAD
    buffer_load_dwordx4 v[8:11], v1, s[28:31], s36 offen
P_NOLOAD:
    s_mov_b64 exec, s[40:41]
    v_cmp_gt_u32 vcc, 128, v0
    s_and_saveexec_b64 s[42:43], vcc
    ds_write_b32 v4, v5
    s_mov_b64 exec, s[42:43]
    v_add_u32 v68, 0, v0
    v_mul_u32_u24 v72, 43691, v68
    v_lshrrev_b32 v72, 20, v72
    v_mul_u32_u24 v64, 24, v72
    v_sub_u32 v68, v68, v64
    v_mul_u32_u24 v76, 24576, v72
    v_lshl_add_u32 v76, v68, 4, v76
    v_add_u32 v69, 640, v0
    v_mul_u32_u24 v73, 43691, v69
    v_lshrrev_b32 v73, 20, v73
    v_mul_u32_u24 v64, 24, v73
    v_sub_u32 v69, v69, v64
    v_mul_u32_u24 v77, 24576, v73
    v_lshl_add_u32 v77, v69, 4, v77
    v_add_u32 v70, 1280, v0
    v_mul_u32_u24 v74, 43691, v70
    v_lshrrev_b32 v74, 20, v74
    v_mul_u32_u24 v64, 24, v74
    v_sub_u32 v70, v70, v64
    v_mul_u32_u24 v78, 24576, v74
    v_lshl_add_u32 v78, v70, 4, v78
    s_waitcnt lgkmcnt(0)
    s_barrier
    v_cmp_gt_u32 vcc, 625, v0
    s_and_saveexec_b64 s[40:41], vcc
    s_cbranch_execz P_NOWORK
    buffer_load_dwordx4 v[12:15], v1, s[24:27], s36 offen
    buffer_load_dwordx2 v[16:17], v3, s[20:23], s38 offen
    buffer_load_dwordx4 v[20:23], v2, s[16:19], s37 offen
    buffer_load_dwordx2 v[24:25], v2, s[16:19], s37 offen offset:16
    s_waitcnt vmcnt(4)
    v_lshl_add_u32 v26, v8, 4, 15
    v_lshl_add_u32 v27, v9, 4, 15
    v_lshl_add_u32 v28, v10, 4, 15
    v_lshl_add_u32 v29, v11, 4, 15
    v_mul_hi_u32 v26, v26, s39
    v_mul_hi_u32 v27, v27, s39
    v_mul_hi_u32 v28, v28, s39
    v_mul_hi_u32 v29, v29, s39
    v_subrev_u32 v26, s49, v26
    v_subrev_u32 v27, s49, v27
    v_subrev_u32 v28, s49, v28
    v_subrev_u32 v29, s49, v29
    v_lshlrev_b32 v34, 2, v26
    v_lshlrev_b32 v35, 2, v27
    v_lshlrev_b32 v36, 2, v28
    v_lshlrev_b32 v37, 2, v29
    v_cmp_gt_u32 s[52:53], 64, v26
    v_cmp_gt_u32 s[54:55], 64, v27
    v_cmp_gt_u32 s[56:57], 64, v28
    v_cmp_gt_u32 s[58:59], 64, v29
    s_mov_b64 s[50:51], exec
    s_mov_b64 exec, s[52:53]
    ds_add_rtn_u32 v30, v34, v6
    s_mov_b64 exec, s[54:55]
    ds_add_rtn_u32 v31, v35, v6
    s_mov_b64 exec, s[56:57]
    ds_add_rtn_u32 v32, v36, v6
    s_mov_b64 exec, s[58:59]
    ds_add_rtn_u32 v33, v37, v6
    s_mov_b64 exec, s[50:51]
    s_waitcnt vmcnt(3)
    v_lshl_or_b32 v40, v8, 14, v12
    v_lshl_or_b32 v44, v9, 14, v13
    v_lshl_or_b32 v48, v10, 14, v14
    v_lshl_or_b32 v52, v11, 14, v15
    s_waitcnt vmcnt(0)
    s_mov_b32 s39, 0xffff0000
    v_lshlrev_b32 v56, 16, v16
    v_lshlrev_b32 v57, 16, v20
    v_and_b32 v58, s39, v20
    v_lshlrev_b32 v59, 16, v21
    v_mul_f32 v57, v56, v57
    v_mul_f32 v58, v56, v58
    v_mul_f32 v59, v56, v59
    v_cvt_pk_bf16_f32 v42, v56, v57
    v_cvt_pk_bf16_f32 v43, v58, v59
    v_and_b32 v56, s39, v16
    v_and_b32 v57, s39, v21
    v_lshlrev_b32 v58, 16, v22
    v_and_b32 v59, s39, v22
    v_mul_f32 v57, v56, v57
    v_mul_f32 v58, v56, v58
    v_mul_f32 v59, v56, v59
    v_cvt_pk_bf16_f32 v46, v56, v57
    v_cvt_pk_bf16_f32 v47, v58, v59
    v_lshlrev_b32 v56, 16, v17
    v_lshlrev_b32 v57, 16, v23
    v_and_b32 v58, s39, v23
    v_lshlrev_b32 v59, 16, v24
    v_mul_f32 v57, v56, v57
    v_mul_f32 v58, v56, v58
    v_mul_f32 v59, v56, v59
    v_cvt_pk_bf16_f32 v50, v56, v57
    v_cvt_pk_bf16_f32 v51, v58, v59
    v_and_b32 v56, s39, v17
    v_and_b32 v57, s39, v24
    v_lshlrev_b32 v58, 16, v25
    v_and_b32 v59, s39, v25
    v_mul_f32 v57, v56, v57
    v_mul_f32 v58, v56, v58
    v_mul_f32 v59, v56, v59
    v_cvt_pk_bf16_f32 v54, v56, v57
    v_cvt_pk_bf16_f32 v55, v58, v59
    s_mul_i32 s45, s2, 30720
    s_add_u32 s45, s45, 6815744
    v_mul_u32_u24 v60, 384, v26
    v_mul_u32_u24 v61, 384, v27
    v_mul_u32_u24 v62, 384, v28
    v_mul_u32_u24 v63, 384, v29
    s_waitcnt lgkmcnt(0)
    v_mov_b32 v7, 256
    v_lshl_add_u32 v64, v30, 2, v60
    v_lshl_add_u32 v65, v30, 3, v60
    s_mov_b64 exec, s[52:53]
    v_cmp_gt_u32 vcc, 31, v30
    s_and_saveexec_b64 s[42:43], vcc
    ds_write_b32 v64, v40 offset:1024
    ds_write_b64 v65, v[42:43] offset:1152
    s_andn2_b64 exec, s[42:43], exec
    s_cbranch_execz P_NOOVF0
    ds_add_rtn_u32 v64, v7, v6
    s_waitcnt lgkmcnt(0)
    v_lshrrev_b32 v65, 5, v64
    v_and_b32 v64, 31, v64
    v_mul_u32_u24 v65, 384, v65
    v_add_u32 v65, s45, v65
    v_lshl_add_u32 v66, v64, 2, v65
    v_lshl_add_u32 v67, v64, 3, v65
    buffer_store_dword v40, v66, s[32:35], 0 offen
    buffer_store_dwordx2 v[42:43], v67, s[32:35], 0 offen offset:128
P_NOOVF0:
    s_mov_b64 exec, s[50:51]
    v_lshl_add_u32 v64, v31, 2, v61
    v_lshl_add_u32 v65, v31, 3, v61
    s_mov_b64 exec, s[54:55]
    v_cmp_gt_u32 vcc, 31, v31
    s_and_saveexec_b64 s[42:43], vcc
    ds_write_b32 v64, v44 offset:1024
    ds_write_b64 v65, v[46:47] offset:1152
    s_andn2_b64 exec, s[42:43], exec
    s_cbranch_execz P_NOOVF1
    ds_add_rtn_u32 v64, v7, v6
    s_waitcnt lgkmcnt(0)
    v_lshrrev_b32 v65, 5, v64
    v_and_b32 v64, 31, v64
    v_mul_u32_u24 v65, 384, v65
    v_add_u32 v65, s45, v65
    v_lshl_add_u32 v66, v64, 2, v65
    v_lshl_add_u32 v67, v64, 3, v65
    buffer_store_dword v44, v66, s[32:35], 0 offen
    buffer_store_dwordx2 v[46:47], v67, s[32:35], 0 offen offset:128
P_NOOVF1:
    s_mov_b64 exec, s[50:51]
    v_lshl_add_u32 v64, v32, 2, v62
    v_lshl_add_u32 v65, v32, 3, v62
    s_mov_b64 exec, s[56:57]
    v_cmp_gt_u32 vcc, 31, v32
    s_and_saveexec_b64 s[42:43], vcc
    ds_write_b32 v64, v48 offset:1024
    ds_write_b64 v65, v[50:51] offset:1152
    s_andn2_b64 exec, s[42:43], exec
    s_cbranch_execz P_NOOVF2
    ds_add_rtn_u32 v64, v7, v6
    s_waitcnt lgkmcnt(0)
    v_lshrrev_b32 v65, 5, v64
    v_and_b32 v64, 31, v64
    v_mul_u32_u24 v65, 384, v65
    v_add_u32 v65, s45, v65
    v_lshl_add_u32 v66, v64, 2, v65
    v_lshl_add_u32 v67, v64, 3, v65
    buffer_store_dword v48, v66, s[32:35], 0 offen
    buffer_store_dwordx2 v[50:51], v67, s[32:35], 0 offen offset:128
P_NOOVF2:
    s_mov_b64 exec, s[50:51]
    v_lshl_add_u32 v64, v33, 2, v63
    v_lshl_add_u32 v65, v33, 3, v63
    s_mov_b64 exec, s[58:59]
    v_cmp_gt_u32 vcc, 31, v33
    s_and_saveexec_b64 s[42:43], vcc
    ds_write_b32 v64, v52 offset:1024
    ds_write_b64 v65, v[54:55] offset:1152
    s_andn2_b64 exec, s[42:43], exec
    s_cbranch_execz P_NOOVF3
    ds_add_rtn_u32 v64, v7, v6
    s_waitcnt lgkmcnt(0)
    v_lshrrev_b32 v65, 5, v64
    v_and_b32 v64, 31, v64
    v_mul_u32_u24 v65, 384, v65
    v_add_u32 v65, s45, v65
    v_lshl_add_u32 v66, v64, 2, v65
    v_lshl_add_u32 v67, v64, 3, v65
    buffer_store_dword v52, v66, s[32:35], 0 offen
    buffer_store_dwordx2 v[54:55], v67, s[32:35], 0 offen offset:128
P_NOOVF3:
    s_mov_b64 exec, s[50:51]
P_NOWORK:
    s_mov_b64 exec, s[40:41]
    s_waitcnt lgkmcnt(0)
    s_barrier
    s_mul_i32 s44, s47, 384
    s_mul_i32 s46, s49, 24576
    s_add_u32 s44, s44, s46
    v_lshlrev_b32 v8, 4, v0
    ds_read_b128 v[16:19], v8 offset:1024
    ds_read_b128 v[20:23], v8 offset:11264
    ds_read_b128 v[24:27], v8 offset:21504
    v_lshlrev_b32 v36, 2, v72
    ds_read_b32 v40, v36
    v_lshlrev_b32 v37, 2, v73
    ds_read_b32 v41, v37
    v_lshlrev_b32 v38, 2, v74
    ds_read_b32 v42, v38
    ds_read_b32 v5, v4
    v_cmp_eq_u32 s[58:59], 7, v68
    v_cmp_gt_u32 s[52:53], 16, v68
    v_cmp_gt_u32 s[56:57], 64, v72
    v_mov_b32 v13, 0x40000000
    s_waitcnt lgkmcnt(3)
    v_cmp_lt_u32 s[54:55], 16, v40
    v_cndmask_b32 v19, v19, v40, s[58:59]
    s_or_b64 s[52:53], s[52:53], s[54:55]
    s_and_b64 vcc, s[52:53], s[56:57]
    s_nop 1
    v_cndmask_b32 v12, v13, v76, vcc
    buffer_store_dwordx4 v[16:19], v12, s[32:35], s44 offen sc1
    v_cmp_eq_u32 s[58:59], 7, v69
    v_cmp_gt_u32 s[52:53], 16, v69
    v_cmp_gt_u32 s[56:57], 64, v73
    v_mov_b32 v13, 0x40000000
    s_waitcnt lgkmcnt(2)
    v_cmp_lt_u32 s[54:55], 16, v41
    v_cndmask_b32 v23, v23, v41, s[58:59]
    s_or_b64 s[52:53], s[52:53], s[54:55]
    s_and_b64 vcc, s[52:53], s[56:57]
    s_nop 1
    v_cndmask_b32 v12, v13, v77, vcc
    buffer_store_dwordx4 v[20:23], v12, s[32:35], s44 offen sc1
    v_cmp_eq_u32 s[58:59], 7, v70
    v_cmp_gt_u32 s[52:53], 16, v70
    v_cmp_gt_u32 s[56:57], 64, v74
    v_mov_b32 v13, 0x40000000
    s_waitcnt lgkmcnt(1)
    v_cmp_lt_u32 s[54:55], 16, v42
    v_cndmask_b32 v27, v27, v42, s[58:59]
    s_or_b64 s[52:53], s[52:53], s[54:55]
    s_and_b64 vcc, s[52:53], s[56:57]
    s_nop 1
    v_cndmask_b32 v12, v13, v78, vcc
    buffer_store_dwordx4 v[24:27], v12, s[32:35], s44 offen sc1
    s_lshl_b32 s44, s2, 2
    s_add_u32 s44, s44, 6291200
    s_waitcnt lgkmcnt(0)
    v_cmp_eq_u32 vcc, 64, v0
    s_and_saveexec_b64 s[42:43], vcc
    s_cbranch_execz P_FIN
    buffer_store_dword v5, v4, s[32:35], s44 offen sc1
    s_branch P_FIN
P_WEIGHTS:
    s_load_dwordx4 s[8:11], s[0:1], 40
    s_load_dwordx2 s[12:13], s[0:1], 56
    v_lshrrev_b32 v1, 6, v0
    v_and_b32 v2, 63, v0
    s_mul_i32 s15, s2, 10
    v_readfirstlane_b32 s14, v1
    s_add_u32 s2, s2, 256
    s_add_u32 s15, s15, s14
    s_and_b32 s16, s15, 1
    s_lshr_b32 s17, s15, 1
    s_mul_i32 s18, s17, 52429
    s_lshr_b32 s18, s18, 18
    s_mul_i32 s19, s18, 5
    s_sub_u32 s19, s17, s19
    s_and_b32 s20, s18, 7
    s_lshr_b32 s21, s18, 3
    s_lshl_b32 s22, s21, 6
    s_lshl_b32 s23, s16, 1
    s_add_u32 s22, s22, s23
    v_and_b32 v3, 15, v2
    v_lshrrev_b32 v4, 4, v2
    v_lshl_add_u32 v5, v4, 4, s22
    s_waitcnt lgkmcnt(0)
    s_cmp_lt_u32 s19, 2
    s_cselect_b32 s24, s10, s12
    s_cselect_b32 s25, s11, s13
    s_mov_b32 s26, 98304
    s_cselect_b32 s26, 65536, s26
    s_mov_b32 s27, 0x20000
    s_cselect_b32 s28, 0, 2
    s_sub_u32 s28, s19, s28
    s_mov_b32 s36, s8
    s_mov_b32 s37, s9
    s_mov_b32 s38, 0x500
    s_mov_b32 s39, 0x20000
    s_mov_b32 s32, s6
    s_mov_b32 s33, s7
    s_mov_b32 s34, 0xe00000
    s_mov_b32 s35, 0x20000
    s_lshl_b32 s29, s28, 7
    v_add_u32 v6, s29, v5
    v_lshlrev_b32 v6, 8, v6
    s_lshl_b32 s30, s20, 4
    v_add_u32 v7, s30, v3
    v_lshl_add_u32 v6, v7, 1, v6
    s_lshl_b32 s31, s19, 7
    v_add_u32 v8, s31, v5
    v_lshlrev_b32 v8, 1, v8
    s_getpc_b64 s[42:43]
P_PC:
    s_add_u32 s42, s42, gather_scatter__tensor_product_equiv_equiformer__graph_kernel-P_PC
    s_addc_u32 s43, s43, 0
    v_lshlrev_b32 v40, 7, v2
    s_cmp_lt_u32 s14, 2
    s_cbranch_scc0 P_NOCPF
    s_lshl_b32 s44, s14, 13
    v_add_u32 v40, s44, v40
    v_min_u32 v40, K_END-gather_scatter__tensor_product_equiv_equiformer__graph_kernel, v40
    global_load_dword v41, v40, s[42:43]
P_NOCPF:
    buffer_load_ushort v10, v6, s[24:27], 0 offen offset:0
    buffer_load_ushort v11, v6, s[24:27], 0 offen offset:1024
    buffer_load_ushort v12, v6, s[24:27], 0 offen offset:256
    buffer_load_ushort v13, v6, s[24:27], 0 offen offset:1280
    buffer_load_ushort v14, v6, s[24:27], 0 offen offset:2048
    buffer_load_ushort v15, v6, s[24:27], 0 offen offset:3072
    buffer_load_ushort v16, v6, s[24:27], 0 offen offset:2304
    buffer_load_ushort v17, v6, s[24:27], 0 offen offset:3328
    buffer_load_ushort v18, v8, s[36:39], 0 offen offset:0
    buffer_load_ushort v19, v8, s[36:39], 0 offen offset:8
    buffer_load_ushort v20, v8, s[36:39], 0 offen offset:2
    buffer_load_ushort v21, v8, s[36:39], 0 offen offset:10
    buffer_load_ushort v22, v8, s[36:39], 0 offen offset:16
    buffer_load_ushort v23, v8, s[36:39], 0 offen offset:24
    buffer_load_ushort v24, v8, s[36:39], 0 offen offset:18
    buffer_load_ushort v25, v8, s[36:39], 0 offen offset:26
    s_waitcnt vmcnt(0)
    v_lshlrev_b32 v10, 16, v10
    v_lshlrev_b32 v11, 16, v11
    v_lshlrev_b32 v12, 16, v12
    v_lshlrev_b32 v13, 16, v13
    v_lshlrev_b32 v14, 16, v14
    v_lshlrev_b32 v15, 16, v15
    v_lshlrev_b32 v16, 16, v16
    v_lshlrev_b32 v17, 16, v17
    v_lshlrev_b32 v18, 16, v18
    v_lshlrev_b32 v19, 16, v19
    v_lshlrev_b32 v20, 16, v20
    v_lshlrev_b32 v21, 16, v21
    v_lshlrev_b32 v22, 16, v22
    v_lshlrev_b32 v23, 16, v23
    v_lshlrev_b32 v24, 16, v24
    v_lshlrev_b32 v25, 16, v25
    v_mul_f32 v10, v10, v18
    v_mul_f32 v11, v11, v19
    v_mul_f32 v12, v12, v20
    v_mul_f32 v13, v13, v21
    v_mul_f32 v14, v14, v22
    v_mul_f32 v15, v15, v23
    v_mul_f32 v16, v16, v24
    v_mul_f32 v17, v17, v25
    v_cvt_pk_bf16_f32 v28, v10, v11
    v_cvt_pk_bf16_f32 v29, v12, v13
    v_cvt_pk_bf16_f32 v30, v14, v15
    v_cvt_pk_bf16_f32 v31, v16, v17
    s_lshl_b32 s40, s15, 10
    s_add_u32 s40, s40, 6422528
    v_lshlrev_b32 v9, 4, v2
    buffer_store_dwordx4 v[28:31], v9, s[32:35], s40 offen sc1
P_FIN:
P_END:
    s_endpgm
.globl gather_scatter__tensor_product_equiv_equiformer__graph_kernel
.p2align 8
.type gather_scatter__tensor_product_equiv_equiformer__graph_kernel,@function
gather_scatter__tensor_product_equiv_equiformer__graph_kernel:
    s_cmp_ge_u32 s2, 256
    s_cbranch_scc1 K_END
    s_load_dwordx2 s[8:9], s[0:1], 88
    s_load_dwordx2 s[4:5], s[0:1], 0
    s_load_dwordx2 s[12:13], s[0:1], 72
    v_lshrrev_b32 v1, 6, v0
    s_mul_i32 s21, s2, 625
    s_add_u32 s23, s21, 625
    v_readfirstlane_b32 s16, v1
    s_lshr_b32 s21, s21, 4
    s_lshr_b32 s23, s23, 4
    s_sub_u32 s23, s23, s21
    s_mov_b32 s17, 0
    s_mov_b32 s20, 1
    s_mov_b32 s27, 1
    s_mov_b32 s18, 0
    s_mov_b32 s19, 0
    s_mov_b32 s22, 0
    v_lshrrev_b32 v1, 4, v0
    v_and_b32 v2, 15, v0
    s_mul_i32 s48, s2, 24576
    v_mul_u32_u24 v3, 384, v1
    v_add_u32 v3, s48, v3
    v_lshl_add_u32 v6, v2, 3, v3
    v_lshl_add_u32 v4, v2, 4, v3
    s_waitcnt lgkmcnt(0)
    s_mov_b32 s10, 0xe00000
    s_mov_b32 s11, 0x20000
    buffer_load_dwordx2 v[16:17], v6, s[8:11], 0 offen
    s_mov_b32 exec_lo, 0x00ff00ff
    s_mov_b32 exec_hi, 0x00ff00ff
    buffer_load_dwordx4 v[18:21], v4, s[8:11], 0 offen offset:128
    s_mov_b64 exec, -1
    s_mov_b32 s6, 0x9c4000
    s_mov_b32 s7, 0x20000
    s_mov_b32 s14, 0x9c4000
    s_mov_b32 s15, 0x20000
    v_mov_b32 v120, 0x40000000
    s_cmp_ge_u32 s16, 8
    s_cbranch_scc1 K_INIT
    v_and_b32 v15, 63, v0
    v_and_b32 v42, 15, v15
    v_lshrrev_b32 v43, 4, v15
    v_lshrrev_b32 v44, 3, v42
    v_and_b32 v45, 7, v42
    v_lshlrev_b32 v112, 8, v44
    v_lshl_add_u32 v112, v45, 4, v112
    v_and_b32 v46, 3, v15
    v_lshlrev_b32 v113, 4, v43
    v_lshl_add_u32 v113, v46, 2, v113
    v_add_u32 v113, 115200, v113
    v_bfe_u32 v46, v15, 2, 2
    v_and_b32 v47, 1, v46
    v_cmp_eq_u32 vcc, 0, v47
    v_mov_b32 v48, 0x01000c0c
    v_mov_b32 v49, 0x0c0c0100
    v_cndmask_b32 v47, v48, v49, vcc
    v_cmp_gt_u32 vcc, 2, v46
    v_mov_b32 v48, 0x0c0c0c0c
    v_mov_b32 v118, 1
    v_cndmask_b32 v114, v48, v47, vcc
    v_cndmask_b32 v115, v47, v48, vcc
    v_cmp_eq_u32 vcc, 0, v44
    v_mov_b32 v48, -1.0
    v_mov_b32 v49, 1.0
    v_cndmask_b32 v116, v48, v49, vcc
    v_and_b32 v46, 1, v43
    v_lshl_add_u32 v46, v45, 1, v46
    v_lshrrev_b32 v47, 1, v43
    v_lshl_add_u32 v46, v47, 4, v46
    v_lshlrev_b32 v46, 2, v46
    v_lshlrev_b32 v47, 6, v44
    v_xor_b32 v46, v46, v47
    v_lshl_add_u32 v117, v44, 7, v46
    v_mov_b32 v119, 146180
    v_add_u32 v46, 32, v15
    v_subrev_u32 v47, 40, v46
    v_cmp_gt_u32 vcc, 40, v46
    v_mov_b32 v32, 0
    v_mov_b32 v33, 0
    v_cndmask_b32 v46, v47, v46, vcc
    v_and_b32 v46, 63, v46
    v_mul_u32_u24 v121, 1440, v46
    v_lshrrev_b32 v47, 4, v46
    v_lshl_or_b32 v121, v47, 17, v121
    v_lshl_or_b32 v121, v46, 24, v121
    v_lshlrev_b32 v56, 2, v46
    v_add_u32 v56, 145920, v56
    v_mov_b32 v36, 0
    v_mov_b32 v37, 0
    v_mov_b32 v40, 0
    v_mov_b32 v41, 0
    s_movk_i32 s35, 0x400
    s_branch K_INIT
K_BATCH:
    v_lshrrev_b32 v1, 4, v0
    v_and_b32 v2, 15, v0
    s_mul_i32 s48, s2, 24576
    v_mul_u32_u24 v3, 384, v1
    v_add_u32 v3, s48, v3
    s_cmp_eq_u32 s17, 2
    s_cbranch_scc0 K_ADDR_DONE
    s_and_b32 s48, s2, 0xc0
    s_add_u32 s48, s48, s18
    s_mul_i32 s48, s48, 30720
    s_mul_i32 s49, s19, 384
    s_add_u32 s48, s48, s49
    s_add_u32 s48, s48, 6815744
    v_mov_b32 v3, s48
K_ADDR_DONE:
    v_lshl_add_u32 v6, v2, 3, v3
    v_lshl_add_u32 v4, v2, 4, v3
    buffer_load_dwordx2 v[16:17], v6, s[8:11], 0 offen
    s_mov_b32 exec_lo, 0x00ff00ff
    s_mov_b32 exec_hi, 0x00ff00ff
    buffer_load_dwordx4 v[18:21], v4, s[8:11], 0 offen offset:128
    s_mov_b64 exec, -1
K_INIT:
    v_lshlrev_b32 v6, 2, v0
    v_lshlrev_b32 v7, 4, v0
    v_mov_b32 v8, 0x3fff0000
    v_mov_b32 v9, 0x3fff0000
    v_mov_b32 v10, 0x3fff0000
    v_mov_b32 v11, 0x3fff0000
    v_add_u32 v7, 115200, v7
    v_mov_b32 v12, 0
    v_add_u32 v13, 145920, v6
    ds_write_b128 v7, v[8:11]
    v_cmp_gt_u32 vcc, 896, v0
    s_and_saveexec_b64 s[56:57], vcc
    ds_write_b128 v7, v[8:11] offset:16384
    s_mov_b64 exec, s[56:57]
    v_cmp_gt_u32 vcc, 80, v0
    s_and_saveexec_b64 s[56:57], vcc
    ds_write_b32 v13, v12
    s_mov_b64 exec, s[56:57]
    v_lshlrev_b32 v7, 1, v2
    s_waitcnt lgkmcnt(0)
    s_barrier
    s_waitcnt vmcnt(1)
    v_mov_b32_dpp v5, v17 row_newbcast:15 row_mask:0xf bank_mask:0xf
    v_bfe_u32 v22, v16, 14, 14
    v_bfe_u32 v23, v17, 14, 14
    v_min_u32 v6, 31, v5
    v_sub_u32 v6, v6, v7
    v_subrev_u32 v22, s21, v22
    v_subrev_u32 v23, s21, v23
    s_cmp_eq_u32 s17, 0
    s_cbranch_scc1 K_LIM_DONE
    s_cmp_eq_u32 s17, 1
    s_cbranch_scc1 K_LIM_A
    s_cmp_eq_u32 s17, 2
    s_cbranch_scc1 K_LIM_B
    v_mov_b32 v6, 0
    s_branch K_LIM_SLOW
K_LIM_A:
    v_cmp_eq_u32 vcc, s18, v1
    s_nop 1
    v_cndmask_b32 v6, 0, v6, vcc
    s_branch K_LIM_SLOW
K_LIM_B:
    s_lshl_b32 s48, s19, 5
    s_sub_u32 s48, s22, s48
    v_sub_u32 v6, s48, v7
    v_cmp_gt_u32 vcc, 16, v0
    s_nop 1
    v_cndmask_b32 v6, 0, v6, vcc
K_LIM_SLOW:
    v_mov_b32 v5, 0
K_LIM_DONE:
    v_cmp_lt_u32 s[62:63], 7, v2
    v_cmp_lt_i32 s[60:61], 0, v6
    v_lshlrev_b32 v24, 2, v22
    v_lshlrev_b32 v25, 2, v23
    s_and_b64 vcc, s[60:61], s[62:63]
    s_and_saveexec_b64 s[56:57], vcc
    s_cbranch_execz K_NOSEC
    buffer_load_dwordx4 v[18:21], v4, s[8:11], 0 offen offset:128
K_NOSEC:
    s_mov_b64 exec, s[56:57]
    s_sub_u32 s50, s16, 8
    s_cmp_lt_u32 s50, 3
    s_cbranch_scc0 K_NOWARM
    s_mul_i32 s49, s2, 157
    s_lshl_b32 s48, s50, 6
    v_and_b32 v36, 63, v0
    v_add_u32 v36, s48, v36
    v_cmp_gt_u32 vcc, 157, v36
    v_add_u32 v36, s49, v36
    v_lshrrev_b32 v37, 2, v36
    v_and_b32 v36, 3, v36
    v_lshlrev_b32 v37, 10, v37
    v_lshl_add_u32 v36, v36, 8, v37
    v_mov_b32 v37, 0x40000000
    v_cndmask_b32 v36, v37, v36, vcc
    buffer_load_dword v38, v36, s[4:7], 0 offen offset:0
K_NOWARM:
    v_mov_b32 v8, 1
    v_cmp_gt_u32 vcc, s23, v22
    v_add_u32 v26, 145920, v24
    v_add_u32 v27, 145920, v25
    s_and_b64 s[60:61], s[60:61], vcc
    v_cmp_lt_i32 s[62:63], 1, v6
    v_cmp_gt_u32 vcc, s23, v23
    s_and_b64 s[62:63], s[62:63], vcc
    s_mov_b64 exec, s[60:61]
    ds_add_rtn_u32 v28, v26, v8
    s_mov_b64 exec, s[62:63]
    ds_add_rtn_u32 v29, v27, v8
    s_mov_b64 exec, -1
    v_and_b32 v1, 0x3fff, v16
    v_and_b32 v2, 0x3fff, v17
    v_lshlrev_b32 v1, 16, v1
    v_lshlrev_b32 v2, 16, v2
    v_mul_u32_u24 v22, 768, v22
    v_mul_u32_u24 v23, 768, v23
    s_mov_b32 s50, 0x07060100
    s_mov_b32 s51, 0x07060302
    v_add_u32 v22, 115200, v22
    v_add_u32 v23, 115200, v23
    s_sub_u32 s52, s16, 8
    s_cmp_lt_u32 s52, 3
    s_cbranch_scc0 K_CW0
    s_waitcnt vmcnt(1)
    s_branch K_CW1
K_CW0:
    s_waitcnt vmcnt(0)
K_CW1:
    v_perm_b32 v8, v1, v18, s50
    v_perm_b32 v9, v1, v18, s51
    v_perm_b32 v10, v1, v19, s50
    v_perm_b32 v11, v1, v19, s51
    v_perm_b32 v12, v2, v20, s50
    v_perm_b32 v13, v2, v20, s51
    v_perm_b32 v14, v2, v21, s50
    v_perm_b32 v15, v2, v21, s51
    s_waitcnt lgkmcnt(0)
    v_lshl_add_u32 v22, v28, 4, v22
    v_lshl_add_u32 v23, v29, 4, v23
    v_cmp_gt_u32 vcc, 48, v28
    v_cmp_lt_u32 s[52:53], 31, v5
    s_andn2_b64 s[54:55], s[60:61], vcc
    s_and_b64 s[60:61], s[60:61], vcc
    v_cmp_gt_u32 vcc, 48, v29
    s_or_b64 s[52:53], s[52:53], s[54:55]
    s_andn2_b64 s[54:55], s[62:63], vcc
    s_and_b64 s[62:63], s[62:63], vcc
    s_or_b64 s[52:53], s[52:53], s[54:55]
    v_mov_b32 v3, 146176
    s_mov_b64 exec, s[60:61]
    ds_write_b128 v22, v[8:11]
    s_mov_b64 exec, s[62:63]
    ds_write_b128 v23, v[12:15]
    s_mov_b64 exec, s[52:53]
    ds_write_b32 v3, v3
    s_mov_b64 exec, -1
    s_waitcnt lgkmcnt(0)
    s_barrier
    ds_read_b32 v5, v3
    s_cmp_ge_u32 s16, 8
    s_cbranch_scc1 K_M
    ds_read_b32 v6, v56
    s_setprio 0
    v_mov_b32 v51, 0x3fff0000
    v_mov_b32 v126, -1
    v_mov_b32 v124, v113
    s_mov_b32 m0, 0
    s_mov_b32 s34, 0
    s_mov_b32 s25, 0
    s_mov_b32 s26, 0
    s_mov_b32 s32, 3
    s_mov_b32 s33, -1
    s_waitcnt lgkmcnt(0)
    v_readfirstlane_b32 s48, v5
    v_add_u32 v6, 3, v6
    v_lshrrev_b32 v6, 2, v6
    v_max_u32 v6, 1, v6
    v_add_u32 v6, -1, v6
    v_lshl_or_b32 v122, v6, 20, v121
    s_cmp_eq_u32 s48, 0
    s_cbranch_scc1 G_START
    s_cmp_eq_u32 s17, 0
    s_cbranch_scc1 K_GOSLOW
G_START:
G_BODY0:
    s_waitcnt vmcnt(4)
    v_mfma_f32_16x16x32_bf16 v[16:19], v[34:37], v[60:63], v[16:19]
    s_waitcnt lgkmcnt(0)
    v_mad_u32_u16 v125, v51, s35, v112 op_sel:[1,0,0,0]
    v_perm_b32 v38, v49, v49, v114
    v_mfma_f32_16x16x32_bf16 v[20:23], v[32:35], v[60:63], v[20:23]
    v_perm_b32 v39, v49, v49, v115
    buffer_load_dwordx4 v[84:87], v125, s[4:7], s26 offen
    buffer_load_dwordx4 v[88:91], v125, s[4:7], s26 offen offset:512
    v_mfma_f32_16x16x32_bf16 v[24:27], v[34:37], v[64:67], v[24:27]
    s_sub_u32 s25, s25, 1
    s_cbranch_scc1 G_NEXT0
G_NEXT0_back:
    ds_read_b32 v48, v124 offset:0
G_MID0:
    v_mfma_f32_16x16x32_bf16 v[28:31], v[32:35], v[64:67], v[28:31]
    s_sub_u32 s32, s32, 1
    s_cbranch_scc1 G_EXT0
G_BODY1:
    s_waitcnt vmcnt(4)
    v_mfma_f32_16x16x32_bf16 v[16:19], v[38:41], v[68:71], v[16:19]
    s_waitcnt lgkmcnt(0)
    v_mad_u32_u16 v125, v48, s35, v112 op_sel:[1,0,0,0]
    v_perm_b32 v34, v50, v50, v114
    v_mfma_f32_16x16x32_bf16 v[20:23], v[36:39], v[68:71], v[20:23]
    v_perm_b32 v35, v50, v50, v115
    buffer_load_dwordx4 v[60:63], v125, s[4:7], s26 offen
    buffer_load_dwordx4 v[64:67], v125, s[4:7], s26 offen offset:512
    v_mfma_f32_16x16x32_bf16 v[24:27], v[38:41], v[72:75], v[24:27]
    s_sub_u32 s25, s25, 1
    s_cbranch_scc1 G_NEXT1
G_NEXT1_back:
    ds_read_b32 v49, v124 offset:64
G_MID1:
    v_mfma_f32_16x16x32_bf16 v[28:31], v[36:39], v[72:75], v[28:31]
    s_sub_u32 s32, s32, 1
    s_cbranch_scc1 G_EXT1
G_BODY2:
    s_waitcnt vmcnt(4)
    v_mfma_f32_16x16x32_bf16 v[16:19], v[34:37], v[76:79], v[16:19]
    s_waitcnt lgkmcnt(0)
    v_mad_u32_u16 v125, v49, s35, v112 op_sel:[1,0,0,0]
    v_perm_b32 v38, v51, v51, v114
    v_mfma_f32_16x16x32_bf16 v[20:23], v[32:35], v[76:79], v[20:23]
    v_perm_b32 v39, v51, v51, v115
    buffer_load_dwordx4 v[68:71], v125, s[4:7], s26 offen
    buffer_load_dwordx4 v[72:75], v125, s[4:7], s26 offen offset:512
    v_mfma_f32_16x16x32_bf16 v[24:27], v[34:37], v[80:83], v[24:27]
    s_sub_u32 s25, s25, 1
    s_cbranch_scc1 G_NEXT2
G_NEXT2_back:
    ds_read_b32 v50, v124 offset:128
G_MID2:
    v_mfma_f32_16x16x32_bf16 v[28:31], v[32:35], v[80:83], v[28:31]
    s_sub_u32 s32, s32, 1
    s_cbranch_scc1 G_EXT2
G_BODY3:
    s_waitcnt vmcnt(4)
    v_mfma_f32_16x16x32_bf16 v[16:19], v[38:41], v[84:87], v[16:19]
    s_waitcnt lgkmcnt(0)
    v_mad_u32_u16 v125, v50, s35, v112 op_sel:[1,0,0,0]
    v_perm_b32 v34, v48, v48, v114
    v_mfma_f32_16x16x32_bf16 v[20:23], v[36:39], v[84:87], v[20:23]
    v_perm_b32 v35, v48, v48, v115
    buffer_load_dwordx4 v[76:79], v125, s[4:7], s26 offen
    buffer_load_dwordx4 v[80:83], v125, s[4:7], s26 offen offset:512
    v_mfma_f32_16x16x32_bf16 v[24:27], v[38:41], v[88:91], v[24:27]
    s_sub_u32 s25, s25, 1
    s_cbranch_scc1 G_NEXT3
G_NEXT3_back:
    ds_read_b32 v51, v124 offset:192
G_MID3:
    v_mfma_f32_16x16x32_bf16 v[28:31], v[36:39], v[88:91], v[28:31]
    v_add_u32 v124, 256, v124
    s_sub_u32 s32, s32, 1
    s_cbranch_scc1 G_EXT3
    s_branch G_BODY0
G_BODY0F:
    s_waitcnt vmcnt(4)
    v_mfma_f32_16x16x32_bf16 v[16:19], v[34:37], v[60:63], 0
    s_waitcnt lgkmcnt(0)
    v_mad_u32_u16 v125, v51, s35, v112 op_sel:[1,0,0,0]
    v_perm_b32 v38, v49, v49, v114
    v_mfma_f32_16x16x32_bf16 v[20:23], v[32:35], v[60:63], 0
    v_perm_b32 v39, v49, v49, v115
    buffer_load_dwordx4 v[84:87], v125, s[4:7], s26 offen
    buffer_load_dwordx4 v[88:91], v125, s[4:7], s26 offen offset:512
    v_mfma_f32_16x16x32_bf16 v[24:27], v[34:37], v[64:67], 0
    s_sub_u32 s25, s25, 1
    s_cbranch_scc1 G_NEXT0F
G_NEXT0F_back:
    ds_read_b32 v48, v124 offset:0
G_MID0F:
    v_mfma_f32_16x16x32_bf16 v[28:31], v[32:35], v[64:67], 0
    s_sub_u32 s32, s32, 1
    s_cbranch_scc1 G_EXT0
    s_branch G_BODY1
G_BODY1F:
    s_waitcnt vmcnt(4)
    v_mfma_f32_16x16x32_bf16 v[16:19], v[38:41], v[68:71], 0
    s_waitcnt lgkmcnt(0)
    v_mad_u32_u16 v125, v48, s35, v112 op_sel:[1,0,0,0]
    v_perm_b32 v34, v50, v50, v114
    v_mfma_f32_16x16x32_bf16 v[20:23], v[36:39], v[68:71], 0
    v_perm_b32 v35, v50, v50, v115
    buffer_load_dwordx4 v[60:63], v125, s[4:7], s26 offen
    buffer_load_dwordx4 v[64:67], v125, s[4:7], s26 offen offset:512
    v_mfma_f32_16x16x32_bf16 v[24:27], v[38:41], v[72:75], 0
    s_sub_u32 s25, s25, 1
    s_cbranch_scc1 G_NEXT1F
G_NEXT1F_back:
    ds_read_b32 v49, v124 offset:64
G_MID1F:
    v_mfma_f32_16x16x32_bf16 v[28:31], v[36:39], v[72:75], 0
    s_sub_u32 s32, s32, 1
    s_cbranch_scc1 G_EXT1
    s_branch G_BODY2
G_BODY2F:
    s_waitcnt vmcnt(4)
    v_mfma_f32_16x16x32_bf16 v[16:19], v[34:37], v[76:79], 0
    s_waitcnt lgkmcnt(0)
    v_mad_u32_u16 v125, v49, s35, v112 op_sel:[1,0,0,0]
    v_perm_b32 v38, v51, v51, v114
    v_mfma_f32_16x16x32_bf16 v[20:23], v[32:35], v[76:79], 0
    v_perm_b32 v39, v51, v51, v115
    buffer_load_dwordx4 v[68:71], v125, s[4:7], s26 offen
    buffer_load_dwordx4 v[72:75], v125, s[4:7], s26 offen offset:512
    v_mfma_f32_16x16x32_bf16 v[24:27], v[34:37], v[80:83], 0
    s_sub_u32 s25, s25, 1
    s_cbranch_scc1 G_NEXT2F
G_NEXT2F_back:
    ds_read_b32 v50, v124 offset:128
G_MID2F:
    v_mfma_f32_16x16x32_bf16 v[28:31], v[32:35], v[80:83], 0
    s_sub_u32 s32, s32, 1
    s_cbranch_scc1 G_EXT2
    s_branch G_BODY3
G_BODY3F:
    s_waitcnt vmcnt(4)
    v_mfma_f32_16x16x32_bf16 v[16:19], v[38:41], v[84:87], 0
    s_waitcnt lgkmcnt(0)
    v_mad_u32_u16 v125, v50, s35, v112 op_sel:[1,0,0,0]
    v_perm_b32 v34, v48, v48, v114
    v_mfma_f32_16x16x32_bf16 v[20:23], v[36:39], v[84:87], 0
    v_perm_b32 v35, v48, v48, v115
    buffer_load_dwordx4 v[76:79], v125, s[4:7], s26 offen
    buffer_load_dwordx4 v[80:83], v125, s[4:7], s26 offen offset:512
    v_mfma_f32_16x16x32_bf16 v[24:27], v[38:41], v[88:91], 0
    s_sub_u32 s25, s25, 1
    s_cbranch_scc1 G_NEXT3F
G_NEXT3F_back:
    ds_read_b32 v51, v124 offset:192
G_MID3F:
    v_mfma_f32_16x16x32_bf16 v[28:31], v[36:39], v[88:91], 0
    v_add_u32 v124, 256, v124
    s_sub_u32 s32, s32, 1
    s_cbranch_scc1 G_EXT3
    s_branch G_BODY0
G_NEXT0:
    s_mov_b64 exec, 1
    ds_add_rtn_u32 v123, v119, v118
    s_mov_b64 exec, -1
    s_waitcnt lgkmcnt(0)
    v_readfirstlane_b32 s48, v123
    s_cmp_ge_u32 s48, 80
    s_cbranch_scc1 G_NEXT0_done
    s_cmp_ge_u32 s48, 40
    s_cselect_b32 s26, 128, 0
    s_cselect_b32 s49, 40, 0
    s_cselect_b32 s50, 450816, 0
    s_sub_u32 s48, s48, s49
    v_readlane_b32 s51, v122, s48
    s_add_u32 s51, s51, s50
    s_bfe_u32 s49, s51, 0x60018
    s_bfe_u32 s25, s51, 0x40014
    s_mul_i32 s49, s49, 768
    s_and_b32 s51, s51, 0xffffff
    s_sub_u32 s49, s49, 0
    v_writelane_b32 v126, s51, m0
    v_add_u32 v124, s49, v113
    s_add_u32 m0, m0, 1
    s_branch G_NEXT0_back
G_NEXT0_done:
    v_mov_b32 v48, 0x3fff0000
    s_branch G_MID0D
G_NEXT0F:
    s_mov_b64 exec, 1
    ds_add_rtn_u32 v123, v119, v118
    s_mov_b64 exec, -1
    s_waitcnt lgkmcnt(0)
    v_readfirstlane_b32 s48, v123
    s_cmp_ge_u32 s48, 80
    s_cbranch_scc1 G_NEXT0F_done
    s_cmp_ge_u32 s48, 40
    s_cselect_b32 s26, 128, 0
    s_cselect_b32 s49, 40, 0
    s_cselect_b32 s50, 450816, 0
    s_sub_u32 s48, s48, s49
    v_readlane_b32 s51, v122, s48
    s_add_u32 s51, s51, s50
    s_bfe_u32 s49, s51, 0x60018
    s_bfe_u32 s25, s51, 0x40014
    s_mul_i32 s49, s49, 768
    s_and_b32 s51, s51, 0xffffff
    s_sub_u32 s49, s49, 0
    v_writelane_b32 v126, s51, m0
    v_add_u32 v124, s49, v113
    s_add_u32 m0, m0, 1
    s_branch G_NEXT0F_back
G_NEXT0F_done:
    v_mov_b32 v48, 0x3fff0000
    s_branch G_MID0FD
G_NEXT1:
    s_mov_b64 exec, 1
    ds_add_rtn_u32 v123, v119, v118
    s_mov_b64 exec, -1
    s_waitcnt lgkmcnt(0)
    v_readfirstlane_b32 s48, v123
    s_cmp_ge_u32 s48, 80
    s_cbranch_scc1 G_NEXT1_done
    s_cmp_ge_u32 s48, 40
    s_cselect_b32 s26, 128, 0
    s_cselect_b32 s49, 40, 0
    s_cselect_b32 s50, 450816, 0
    s_sub_u32 s48, s48, s49
    v_readlane_b32 s51, v122, s48
    s_add_u32 s51, s51, s50
    s_bfe_u32 s49, s51, 0x60018
    s_bfe_u32 s25, s51, 0x40014
    s_mul_i32 s49, s49, 768
    s_and_b32 s51, s51, 0xffffff
    s_sub_u32 s49, s49, 64
    v_writelane_b32 v126, s51, m0
    v_add_u32 v124, s49, v113
    s_add_u32 m0, m0, 1
    s_branch G_NEXT1_back
G_NEXT1_done:
    v_mov_b32 v49, 0x3fff0000
    s_branch G_MID1D
G_NEXT1F:
    s_mov_b64 exec, 1
    ds_add_rtn_u32 v123, v119, v118
    s_mov_b64 exec, -1
    s_waitcnt lgkmcnt(0)
    v_readfirstlane_b32 s48, v123
    s_cmp_ge_u32 s48, 80
    s_cbranch_scc1 G_NEXT1F_done
    s_cmp_ge_u32 s48, 40
    s_cselect_b32 s26, 128, 0
    s_cselect_b32 s49, 40, 0
    s_cselect_b32 s50, 450816, 0
    s_sub_u32 s48, s48, s49
    v_readlane_b32 s51, v122, s48
    s_add_u32 s51, s51, s50
    s_bfe_u32 s49, s51, 0x60018
    s_bfe_u32 s25, s51, 0x40014
    s_mul_i32 s49, s49, 768
    s_and_b32 s51, s51, 0xffffff
    s_sub_u32 s49, s49, 64
    v_writelane_b32 v126, s51, m0
    v_add_u32 v124, s49, v113
    s_add_u32 m0, m0, 1
    s_branch G_NEXT1F_back
G_NEXT1F_done:
    v_mov_b32 v49, 0x3fff0000
    s_branch G_MID1FD
G_NEXT2:
    s_mov_b64 exec, 1
    ds_add_rtn_u32 v123, v119, v118
    s_mov_b64 exec, -1
    s_waitcnt lgkmcnt(0)
    v_readfirstlane_b32 s48, v123
    s_cmp_ge_u32 s48, 80
    s_cbranch_scc1 G_NEXT2_done
    s_cmp_ge_u32 s48, 40
    s_cselect_b32 s26, 128, 0
    s_cselect_b32 s49, 40, 0
    s_cselect_b32 s50, 450816, 0
    s_sub_u32 s48, s48, s49
    v_readlane_b32 s51, v122, s48
    s_add_u32 s51, s51, s50
    s_bfe_u32 s49, s51, 0x60018
    s_bfe_u32 s25, s51, 0x40014
    s_mul_i32 s49, s49, 768
    s_and_b32 s51, s51, 0xffffff
    s_sub_u32 s49, s49, 128
    v_writelane_b32 v126, s51, m0
    v_add_u32 v124, s49, v113
    s_add_u32 m0, m0, 1
    s_branch G_NEXT2_back
G_NEXT2_done:
    v_mov_b32 v50, 0x3fff0000
    s_branch G_MID2D
G_NEXT2F:
    s_mov_b64 exec, 1
    ds_add_rtn_u32 v123, v119, v118
    s_mov_b64 exec, -1
    s_waitcnt lgkmcnt(0)
    v_readfirstlane_b32 s48, v123
    s_cmp_ge_u32 s48, 80
    s_cbranch_scc1 G_NEXT2F_done
    s_cmp_ge_u32 s48, 40
    s_cselect_b32 s26, 128, 0
    s_cselect_b32 s49, 40, 0
    s_cselect_b32 s50, 450816, 0
    s_sub_u32 s48, s48, s49
    v_readlane_b32 s51, v122, s48
    s_add_u32 s51, s51, s50
    s_bfe_u32 s49, s51, 0x60018
    s_bfe_u32 s25, s51, 0x40014
    s_mul_i32 s49, s49, 768
    s_and_b32 s51, s51, 0xffffff
    s_sub_u32 s49, s49, 128
    v_writelane_b32 v126, s51, m0
    v_add_u32 v124, s49, v113
    s_add_u32 m0, m0, 1
    s_branch G_NEXT2F_back
G_NEXT2F_done:
    v_mov_b32 v50, 0x3fff0000
    s_branch G_MID2FD
G_NEXT3:
    s_mov_b64 exec, 1
    ds_add_rtn_u32 v123, v119, v118
    s_mov_b64 exec, -1
    s_waitcnt lgkmcnt(0)
    v_readfirstlane_b32 s48, v123
    s_cmp_ge_u32 s48, 80
    s_cbranch_scc1 G_NEXT3_done
    s_cmp_ge_u32 s48, 40
    s_cselect_b32 s26, 128, 0
    s_cselect_b32 s49, 40, 0
    s_cselect_b32 s50, 450816, 0
    s_sub_u32 s48, s48, s49
    v_readlane_b32 s51, v122, s48
    s_add_u32 s51, s51, s50
    s_bfe_u32 s49, s51, 0x60018
    s_bfe_u32 s25, s51, 0x40014
    s_mul_i32 s49, s49, 768
    s_and_b32 s51, s51, 0xffffff
    s_sub_u32 s49, s49, 192
    v_writelane_b32 v126, s51, m0
    v_add_u32 v124, s49, v113
    s_add_u32 m0, m0, 1
    s_branch G_NEXT3_back
G_NEXT3_done:
    v_mov_b32 v51, 0x3fff0000
    s_branch G_MID3D
G_NEXT3F:
    s_mov_b64 exec, 1
    ds_add_rtn_u32 v123, v119, v118
    s_mov_b64 exec, -1
    s_waitcnt lgkmcnt(0)
    v_readfirstlane_b32 s48, v123
    s_cmp_ge_u32 s48, 80
    s_cbranch_scc1 G_NEXT3F_done
    s_cmp_ge_u32 s48, 40
    s_cselect_b32 s26, 128, 0
    s_cselect_b32 s49, 40, 0
    s_cselect_b32 s50, 450816, 0
    s_sub_u32 s48, s48, s49
    v_readlane_b32 s51, v122, s48
    s_add_u32 s51, s51, s50
    s_bfe_u32 s49, s51, 0x60018
    s_bfe_u32 s25, s51, 0x40014
    s_mul_i32 s49, s49, 768
    s_and_b32 s51, s51, 0xffffff
    s_sub_u32 s49, s49, 192
    v_writelane_b32 v126, s51, m0
    v_add_u32 v124, s49, v113
    s_add_u32 m0, m0, 1
    s_branch G_NEXT3F_back
G_NEXT3F_done:
    v_mov_b32 v51, 0x3fff0000
    s_branch G_MID3FD
G_EXT0:
    v_readlane_b32 s50, v126, s34
    s_cmp_eq_u32 s33, -1
    s_cbranch_scc1 G_EXT0_pop
    s_and_b32 s48, s33, 0x1ffff
    s_bfe_u32 s49, s33, 0x30011
    s_lshl_b32 s49, s49, 2
    s_add_u32 s49, s49, 146192
    v_add_u32 v127, s48, v117
    v_mov_b32 v54, s49
    v_fmac_f32_dpp v26, v27, v116 row_ror:8 row_mask:0xf bank_mask:0xf
    v_fmac_f32_dpp v30, v31, v116 row_ror:8 row_mask:0xf bank_mask:0xf
    v_sub_f32_dpp v19, v19, v25 quad_perm:[0,1,2,3] row_mask:0xf bank_mask:0xc
    v_sub_f32_dpp v23, v23, v29 quad_perm:[0,1,2,3] row_mask:0xf bank_mask:0xc
    v_sub_f32_dpp v18, v25, v18 row_ror:8 row_mask:0xf bank_mask:0xc
    v_sub_f32_dpp v22, v29, v22 row_ror:8 row_mask:0xf bank_mask:0xc
    v_add_f32_dpp v26, v17, v26 row_ror:8 row_mask:0xf bank_mask:0x3
    v_add_f32_dpp v30, v21, v30 row_ror:8 row_mask:0xf bank_mask:0x3
    v_cvt_pk_bf16_f32 v42, v16, v20
    v_cvt_pk_bf16_f32 v43, v24, v28
    v_cvt_pk_bf16_f32 v44, v26, v30
    v_cvt_pk_bf16_f32 v45, v19, v23
    v_cvt_pk_bf16_f32 v46, v18, v22
    v_cvt_pk_bf16_f32 v47, v17, v21
    ds_write_b32 v127, v42 offset:0
    ds_write_b32 v127, v43 offset:256
    ds_write_b32 v127, v44 offset:512
    ds_write_b32 v127, v45 offset:768
    ds_write_b32 v127, v46 offset:1024
    s_mov_b32 exec_lo, 0x00ff00ff
    s_mov_b32 exec_hi, 0x00ff00ff
    ds_write_b32 v127, v47 offset:1280
    s_mov_b64 exec, 1
    ds_add_u32 v54, v118
    s_mov_b64 exec, -1
G_EXT0_pop:
    s_add_u32 s34, s34, 1
    s_cmp_eq_u32 s50, -1
    s_cbranch_scc1 G_DONE
    s_and_b32 s33, s50, 0xfffff
    s_lshr_b32 s32, s50, 20
    s_branch G_BODY1F
G_EXT1:
    v_readlane_b32 s50, v126, s34
    s_cmp_eq_u32 s33, -1
    s_cbranch_scc1 G_EXT1_pop
    s_and_b32 s48, s33, 0x1ffff
    s_bfe_u32 s49, s33, 0x30011
    s_lshl_b32 s49, s49, 2
    s_add_u32 s49, s49, 146192
    v_add_u32 v127, s48, v117
    v_mov_b32 v54, s49
    v_fmac_f32_dpp v26, v27, v116 row_ror:8 row_mask:0xf bank_mask:0xf
    v_fmac_f32_dpp v30, v31, v116 row_ror:8 row_mask:0xf bank_mask:0xf
    v_sub_f32_dpp v19, v19, v25 quad_perm:[0,1,2,3] row_mask:0xf bank_mask:0xc
    v_sub_f32_dpp v23, v23, v29 quad_perm:[0,1,2,3] row_mask:0xf bank_mask:0xc
    v_sub_f32_dpp v18, v25, v18 row_ror:8 row_mask:0xf bank_mask:0xc
    v_sub_f32_dpp v22, v29, v22 row_ror:8 row_mask:0xf bank_mask:0xc
    v_add_f32_dpp v26, v17, v26 row_ror:8 row_mask:0xf bank_mask:0x3
    v_add_f32_dpp v30, v21, v30 row_ror:8 row_mask:0xf bank_mask:0x3
    v_cvt_pk_bf16_f32 v42, v16, v20
    v_cvt_pk_bf16_f32 v43, v24, v28
    v_cvt_pk_bf16_f32 v44, v26, v30
    v_cvt_pk_bf16_f32 v45, v19, v23
    v_cvt_pk_bf16_f32 v46, v18, v22
    v_cvt_pk_bf16_f32 v47, v17, v21
    ds_write_b32 v127, v42 offset:0
    ds_write_b32 v127, v43 offset:256
    ds_write_b32 v127, v44 offset:512
    ds_write_b32 v127, v45 offset:768
    ds_write_b32 v127, v46 offset:1024
    s_mov_b32 exec_lo, 0x00ff00ff
    s_mov_b32 exec_hi, 0x00ff00ff
    ds_write_b32 v127, v47 offset:1280
    s_mov_b64 exec, 1
    ds_add_u32 v54, v118
    s_mov_b64 exec, -1
G_EXT1_pop:
    s_add_u32 s34, s34, 1
    s_cmp_eq_u32 s50, -1
    s_cbranch_scc1 G_DONE
    s_and_b32 s33, s50, 0xfffff
    s_lshr_b32 s32, s50, 20
    s_branch G_BODY2F
G_EXT2:
    v_readlane_b32 s50, v126, s34
    s_cmp_eq_u32 s33, -1
    s_cbranch_scc1 G_EXT2_pop
    s_and_b32 s48, s33, 0x1ffff
    s_bfe_u32 s49, s33, 0x30011
    s_lshl_b32 s49, s49, 2
    s_add_u32 s49, s49, 146192
    v_add_u32 v127, s48, v117
    v_mov_b32 v54, s49
    v_fmac_f32_dpp v26, v27, v116 row_ror:8 row_mask:0xf bank_mask:0xf
    v_fmac_f32_dpp v30, v31, v116 row_ror:8 row_mask:0xf bank_mask:0xf
    v_sub_f32_dpp v19, v19, v25 quad_perm:[0,1,2,3] row_mask:0xf bank_mask:0xc
    v_sub_f32_dpp v23, v23, v29 quad_perm:[0,1,2,3] row_mask:0xf bank_mask:0xc
    v_sub_f32_dpp v18, v25, v18 row_ror:8 row_mask:0xf bank_mask:0xc
    v_sub_f32_dpp v22, v29, v22 row_ror:8 row_mask:0xf bank_mask:0xc
    v_add_f32_dpp v26, v17, v26 row_ror:8 row_mask:0xf bank_mask:0x3
    v_add_f32_dpp v30, v21, v30 row_ror:8 row_mask:0xf bank_mask:0x3
    v_cvt_pk_bf16_f32 v42, v16, v20
    v_cvt_pk_bf16_f32 v43, v24, v28
    v_cvt_pk_bf16_f32 v44, v26, v30
    v_cvt_pk_bf16_f32 v45, v19, v23
    v_cvt_pk_bf16_f32 v46, v18, v22
    v_cvt_pk_bf16_f32 v47, v17, v21
    ds_write_b32 v127, v42 offset:0
    ds_write_b32 v127, v43 offset:256
    ds_write_b32 v127, v44 offset:512
    ds_write_b32 v127, v45 offset:768
    ds_write_b32 v127, v46 offset:1024
    s_mov_b32 exec_lo, 0x00ff00ff
    s_mov_b32 exec_hi, 0x00ff00ff
    ds_write_b32 v127, v47 offset:1280
    s_mov_b64 exec, 1
    ds_add_u32 v54, v118
    s_mov_b64 exec, -1
G_EXT2_pop:
    s_add_u32 s34, s34, 1
    s_cmp_eq_u32 s50, -1
    s_cbranch_scc1 G_DONE
    s_and_b32 s33, s50, 0xfffff
    s_lshr_b32 s32, s50, 20
    s_branch G_BODY3F
G_EXT3:
    v_readlane_b32 s50, v126, s34
    s_cmp_eq_u32 s33, -1
    s_cbranch_scc1 G_EXT3_pop
    s_and_b32 s48, s33, 0x1ffff
    s_bfe_u32 s49, s33, 0x30011
    s_lshl_b32 s49, s49, 2
    s_add_u32 s49, s49, 146192
    v_add_u32 v127, s48, v117
    v_mov_b32 v54, s49
    v_fmac_f32_dpp v26, v27, v116 row_ror:8 row_mask:0xf bank_mask:0xf
    v_fmac_f32_dpp v30, v31, v116 row_ror:8 row_mask:0xf bank_mask:0xf
    v_sub_f32_dpp v19, v19, v25 quad_perm:[0,1,2,3] row_mask:0xf bank_mask:0xc
    v_sub_f32_dpp v23, v23, v29 quad_perm:[0,1,2,3] row_mask:0xf bank_mask:0xc
    v_sub_f32_dpp v18, v25, v18 row_ror:8 row_mask:0xf bank_mask:0xc
    v_sub_f32_dpp v22, v29, v22 row_ror:8 row_mask:0xf bank_mask:0xc
    v_add_f32_dpp v26, v17, v26 row_ror:8 row_mask:0xf bank_mask:0x3
    v_add_f32_dpp v30, v21, v30 row_ror:8 row_mask:0xf bank_mask:0x3
    v_cvt_pk_bf16_f32 v42, v16, v20
    v_cvt_pk_bf16_f32 v43, v24, v28
    v_cvt_pk_bf16_f32 v44, v26, v30
    v_cvt_pk_bf16_f32 v45, v19, v23
    v_cvt_pk_bf16_f32 v46, v18, v22
    v_cvt_pk_bf16_f32 v47, v17, v21
    ds_write_b32 v127, v42 offset:0
    ds_write_b32 v127, v43 offset:256
    ds_write_b32 v127, v44 offset:512
    ds_write_b32 v127, v45 offset:768
    ds_write_b32 v127, v46 offset:1024
    s_mov_b32 exec_lo, 0x00ff00ff
    s_mov_b32 exec_hi, 0x00ff00ff
    ds_write_b32 v127, v47 offset:1280
    s_mov_b64 exec, 1
    ds_add_u32 v54, v118
    s_mov_b64 exec, -1
G_EXT3_pop:
    s_add_u32 s34, s34, 1
    s_cmp_eq_u32 s50, -1
    s_cbranch_scc1 G_DONE
    s_and_b32 s33, s50, 0xfffff
    s_lshr_b32 s32, s50, 20
    s_branch G_BODY0F
G_BODY0D:
    s_waitcnt vmcnt(4)
    v_mfma_f32_16x16x32_bf16 v[16:19], v[34:37], v[60:63], v[16:19]
    v_perm_b32 v38, v49, v49, v114
    v_mfma_f32_16x16x32_bf16 v[20:23], v[32:35], v[60:63], v[20:23]
    v_perm_b32 v39, v49, v49, v115
    buffer_load_dword v55, v120, s[4:7], 0 offen
    buffer_load_dword v55, v120, s[4:7], 0 offen
    v_mfma_f32_16x16x32_bf16 v[24:27], v[34:37], v[64:67], v[24:27]
G_MID0D:
    v_mfma_f32_16x16x32_bf16 v[28:31], v[32:35], v[64:67], v[28:31]
    s_sub_u32 s32, s32, 1
    s_cbranch_scc1 G_EXT0D
G_BODY1D:
    s_waitcnt vmcnt(4)
    v_mfma_f32_16x16x32_bf16 v[16:19], v[38:41], v[68:71], v[16:19]
    v_perm_b32 v34, v50, v50, v114
    v_mfma_f32_16x16x32_bf16 v[20:23], v[36:39], v[68:71], v[20:23]
    v_perm_b32 v35, v50, v50, v115
    buffer_load_dword v55, v120, s[4:7], 0 offen
    buffer_load_dword v55, v120, s[4:7], 0 offen
    v_mfma_f32_16x16x32_bf16 v[24:27], v[38:41], v[72:75], v[24:27]
G_MID1D:
    v_mfma_f32_16x16x32_bf16 v[28:31], v[36:39], v[72:75], v[28:31]
    s_sub_u32 s32, s32, 1
    s_cbranch_scc1 G_EXT1D
G_BODY2D:
    s_waitcnt vmcnt(4)
    v_mfma_f32_16x16x32_bf16 v[16:19], v[34:37], v[76:79], v[16:19]
    v_perm_b32 v38, v51, v51, v114
    v_mfma_f32_16x16x32_bf16 v[20:23], v[32:35], v[76:79], v[20:23]
    v_perm_b32 v39, v51, v51, v115
    buffer_load_dword v55, v120, s[4:7], 0 offen
    buffer_load_dword v55, v120, s[4:7], 0 offen
    v_mfma_f32_16x16x32_bf16 v[24:27], v[34:37], v[80:83], v[24:27]
G_MID2D:
    v_mfma_f32_16x16x32_bf16 v[28:31], v[32:35], v[80:83], v[28:31]
    s_sub_u32 s32, s32, 1
    s_cbranch_scc1 G_EXT2D
G_BODY3D:
    s_waitcnt vmcnt(4)
    v_mfma_f32_16x16x32_bf16 v[16:19], v[38:41], v[84:87], v[16:19]
    v_perm_b32 v34, v48, v48, v114
    v_mfma_f32_16x16x32_bf16 v[20:23], v[36:39], v[84:87], v[20:23]
    v_perm_b32 v35, v48, v48, v115
    buffer_load_dword v55, v120, s[4:7], 0 offen
    buffer_load_dword v55, v120, s[4:7], 0 offen
    v_mfma_f32_16x16x32_bf16 v[24:27], v[38:41], v[88:91], v[24:27]
G_MID3D:
    v_mfma_f32_16x16x32_bf16 v[28:31], v[36:39], v[88:91], v[28:31]
    s_sub_u32 s32, s32, 1
    s_cbranch_scc1 G_EXT3D
    s_branch G_BODY0D
G_BODY0FD:
    s_waitcnt vmcnt(4)
    v_mfma_f32_16x16x32_bf16 v[16:19], v[34:37], v[60:63], 0
    v_perm_b32 v38, v49, v49, v114
    v_mfma_f32_16x16x32_bf16 v[20:23], v[32:35], v[60:63], 0
    v_perm_b32 v39, v49, v49, v115
    buffer_load_dword v55, v120, s[4:7], 0 offen
    buffer_load_dword v55, v120, s[4:7], 0 offen
    v_mfma_f32_16x16x32_bf16 v[24:27], v[34:37], v[64:67], 0
G_MID0FD:
    v_mfma_f32_16x16x32_bf16 v[28:31], v[32:35], v[64:67], 0
    s_sub_u32 s32, s32, 1
    s_cbranch_scc1 G_EXT0D
    s_branch G_BODY1D
G_BODY1FD:
    s_waitcnt vmcnt(4)
    v_mfma_f32_16x16x32_bf16 v[16:19], v[38:41], v[68:71], 0
    v_perm_b32 v34, v50, v50, v114
    v_mfma_f32_16x16x32_bf16 v[20:23], v[36:39], v[68:71], 0
    v_perm_b32 v35, v50, v50, v115
    buffer_load_dword v55, v120, s[4:7], 0 offen
    buffer_load_dword v55, v120, s[4:7], 0 offen
    v_mfma_f32_16x16x32_bf16 v[24:27], v[38:41], v[72:75], 0
G_MID1FD:
    v_mfma_f32_16x16x32_bf16 v[28:31], v[36:39], v[72:75], 0
    s_sub_u32 s32, s32, 1
    s_cbranch_scc1 G_EXT1D
    s_branch G_BODY2D
G_BODY2FD:
    s_waitcnt vmcnt(4)
    v_mfma_f32_16x16x32_bf16 v[16:19], v[34:37], v[76:79], 0
    v_perm_b32 v38, v51, v51, v114
    v_mfma_f32_16x16x32_bf16 v[20:23], v[32:35], v[76:79], 0
    v_perm_b32 v39, v51, v51, v115
    buffer_load_dword v55, v120, s[4:7], 0 offen
    buffer_load_dword v55, v120, s[4:7], 0 offen
    v_mfma_f32_16x16x32_bf16 v[24:27], v[34:37], v[80:83], 0
G_MID2FD:
    v_mfma_f32_16x16x32_bf16 v[28:31], v[32:35], v[80:83], 0
    s_sub_u32 s32, s32, 1
    s_cbranch_scc1 G_EXT2D
    s_branch G_BODY3D
G_BODY3FD:
    s_waitcnt vmcnt(4)
    v_mfma_f32_16x16x32_bf16 v[16:19], v[38:41], v[84:87], 0
    v_perm_b32 v34, v48, v48, v114
    v_mfma_f32_16x16x32_bf16 v[20:23], v[36:39], v[84:87], 0
    v_perm_b32 v35, v48, v48, v115
    buffer_load_dword v55, v120, s[4:7], 0 offen
    buffer_load_dword v55, v120, s[4:7], 0 offen
    v_mfma_f32_16x16x32_bf16 v[24:27], v[38:41], v[88:91], 0
G_MID3FD:
    v_mfma_f32_16x16x32_bf16 v[28:31], v[36:39], v[88:91], 0
    s_sub_u32 s32, s32, 1
    s_cbranch_scc1 G_EXT3D
    s_branch G_BODY0D
G_EXT0D:
    v_readlane_b32 s50, v126, s34
    s_cmp_eq_u32 s33, -1
    s_cbranch_scc1 G_EXT0D_pop
    s_and_b32 s48, s33, 0x1ffff
    s_bfe_u32 s49, s33, 0x30011
    s_lshl_b32 s49, s49, 2
    s_add_u32 s49, s49, 146192
    v_add_u32 v127, s48, v117
    v_mov_b32 v54, s49
    v_fmac_f32_dpp v26, v27, v116 row_ror:8 row_mask:0xf bank_mask:0xf
    v_fmac_f32_dpp v30, v31, v116 row_ror:8 row_mask:0xf bank_mask:0xf
    v_sub_f32_dpp v19, v19, v25 quad_perm:[0,1,2,3] row_mask:0xf bank_mask:0xc
    v_sub_f32_dpp v23, v23, v29 quad_perm:[0,1,2,3] row_mask:0xf bank_mask:0xc
    v_sub_f32_dpp v18, v25, v18 row_ror:8 row_mask:0xf bank_mask:0xc
    v_sub_f32_dpp v22, v29, v22 row_ror:8 row_mask:0xf bank_mask:0xc
    v_add_f32_dpp v26, v17, v26 row_ror:8 row_mask:0xf bank_mask:0x3
    v_add_f32_dpp v30, v21, v30 row_ror:8 row_mask:0xf bank_mask:0x3
    v_cvt_pk_bf16_f32 v42, v16, v20
    v_cvt_pk_bf16_f32 v43, v24, v28
    v_cvt_pk_bf16_f32 v44, v26, v30
    v_cvt_pk_bf16_f32 v45, v19, v23
    v_cvt_pk_bf16_f32 v46, v18, v22
    v_cvt_pk_bf16_f32 v47, v17, v21
    ds_write_b32 v127, v42 offset:0
    ds_write_b32 v127, v43 offset:256
    ds_write_b32 v127, v44 offset:512
    ds_write_b32 v127, v45 offset:768
    ds_write_b32 v127, v46 offset:1024
    s_mov_b32 exec_lo, 0x00ff00ff
    s_mov_b32 exec_hi, 0x00ff00ff
    ds_write_b32 v127, v47 offset:1280
    s_mov_b64 exec, 1
    ds_add_u32 v54, v118
    s_mov_b64 exec, -1
G_EXT0D_pop:
    s_add_u32 s34, s34, 1
    s_cmp_eq_u32 s50, -1
    s_cbranch_scc1 G_DONE
    s_and_b32 s33, s50, 0xfffff
    s_lshr_b32 s32, s50, 20
    s_branch G_BODY1FD
G_EXT1D:
    v_readlane_b32 s50, v126, s34
    s_cmp_eq_u32 s33, -1
    s_cbranch_scc1 G_EXT1D_pop
    s_and_b32 s48, s33, 0x1ffff
    s_bfe_u32 s49, s33, 0x30011
    s_lshl_b32 s49, s49, 2
    s_add_u32 s49, s49, 146192
    v_add_u32 v127, s48, v117
    v_mov_b32 v54, s49
    v_fmac_f32_dpp v26, v27, v116 row_ror:8 row_mask:0xf bank_mask:0xf
    v_fmac_f32_dpp v30, v31, v116 row_ror:8 row_mask:0xf bank_mask:0xf
    v_sub_f32_dpp v19, v19, v25 quad_perm:[0,1,2,3] row_mask:0xf bank_mask:0xc
    v_sub_f32_dpp v23, v23, v29 quad_perm:[0,1,2,3] row_mask:0xf bank_mask:0xc
    v_sub_f32_dpp v18, v25, v18 row_ror:8 row_mask:0xf bank_mask:0xc
    v_sub_f32_dpp v22, v29, v22 row_ror:8 row_mask:0xf bank_mask:0xc
    v_add_f32_dpp v26, v17, v26 row_ror:8 row_mask:0xf bank_mask:0x3
    v_add_f32_dpp v30, v21, v30 row_ror:8 row_mask:0xf bank_mask:0x3
    v_cvt_pk_bf16_f32 v42, v16, v20
    v_cvt_pk_bf16_f32 v43, v24, v28
    v_cvt_pk_bf16_f32 v44, v26, v30
    v_cvt_pk_bf16_f32 v45, v19, v23
    v_cvt_pk_bf16_f32 v46, v18, v22
    v_cvt_pk_bf16_f32 v47, v17, v21
    ds_write_b32 v127, v42 offset:0
    ds_write_b32 v127, v43 offset:256
    ds_write_b32 v127, v44 offset:512
    ds_write_b32 v127, v45 offset:768
    ds_write_b32 v127, v46 offset:1024
    s_mov_b32 exec_lo, 0x00ff00ff
    s_mov_b32 exec_hi, 0x00ff00ff
    ds_write_b32 v127, v47 offset:1280
    s_mov_b64 exec, 1
    ds_add_u32 v54, v118
    s_mov_b64 exec, -1
G_EXT1D_pop:
    s_add_u32 s34, s34, 1
    s_cmp_eq_u32 s50, -1
    s_cbranch_scc1 G_DONE
    s_and_b32 s33, s50, 0xfffff
    s_lshr_b32 s32, s50, 20
    s_branch G_BODY2FD
G_EXT2D:
    v_readlane_b32 s50, v126, s34
    s_cmp_eq_u32 s33, -1
    s_cbranch_scc1 G_EXT2D_pop
    s_and_b32 s48, s33, 0x1ffff
    s_bfe_u32 s49, s33, 0x30011
    s_lshl_b32 s49, s49, 2
    s_add_u32 s49, s49, 146192
    v_add_u32 v127, s48, v117
    v_mov_b32 v54, s49
    v_fmac_f32_dpp v26, v27, v116 row_ror:8 row_mask:0xf bank_mask:0xf
    v_fmac_f32_dpp v30, v31, v116 row_ror:8 row_mask:0xf bank_mask:0xf
    v_sub_f32_dpp v19, v19, v25 quad_perm:[0,1,2,3] row_mask:0xf bank_mask:0xc
    v_sub_f32_dpp v23, v23, v29 quad_perm:[0,1,2,3] row_mask:0xf bank_mask:0xc
    v_sub_f32_dpp v18, v25, v18 row_ror:8 row_mask:0xf bank_mask:0xc
    v_sub_f32_dpp v22, v29, v22 row_ror:8 row_mask:0xf bank_mask:0xc
    v_add_f32_dpp v26, v17, v26 row_ror:8 row_mask:0xf bank_mask:0x3
    v_add_f32_dpp v30, v21, v30 row_ror:8 row_mask:0xf bank_mask:0x3
    v_cvt_pk_bf16_f32 v42, v16, v20
    v_cvt_pk_bf16_f32 v43, v24, v28
    v_cvt_pk_bf16_f32 v44, v26, v30
    v_cvt_pk_bf16_f32 v45, v19, v23
    v_cvt_pk_bf16_f32 v46, v18, v22
    v_cvt_pk_bf16_f32 v47, v17, v21
    ds_write_b32 v127, v42 offset:0
    ds_write_b32 v127, v43 offset:256
    ds_write_b32 v127, v44 offset:512
    ds_write_b32 v127, v45 offset:768
    ds_write_b32 v127, v46 offset:1024
    s_mov_b32 exec_lo, 0x00ff00ff
    s_mov_b32 exec_hi, 0x00ff00ff
    ds_write_b32 v127, v47 offset:1280
    s_mov_b64 exec, 1
    ds_add_u32 v54, v118
    s_mov_b64 exec, -1
G_EXT2D_pop:
    s_add_u32 s34, s34, 1
    s_cmp_eq_u32 s50, -1
    s_cbranch_scc1 G_DONE
    s_and_b32 s33, s50, 0xfffff
    s_lshr_b32 s32, s50, 20
    s_branch G_BODY3FD
G_EXT3D:
    v_readlane_b32 s50, v126, s34
    s_cmp_eq_u32 s33, -1
    s_cbranch_scc1 G_EXT3D_pop
    s_and_b32 s48, s33, 0x1ffff
    s_bfe_u32 s49, s33, 0x30011
    s_lshl_b32 s49, s49, 2
    s_add_u32 s49, s49, 146192
    v_add_u32 v127, s48, v117
    v_mov_b32 v54, s49
    v_fmac_f32_dpp v26, v27, v116 row_ror:8 row_mask:0xf bank_mask:0xf
    v_fmac_f32_dpp v30, v31, v116 row_ror:8 row_mask:0xf bank_mask:0xf
    v_sub_f32_dpp v19, v19, v25 quad_perm:[0,1,2,3] row_mask:0xf bank_mask:0xc
    v_sub_f32_dpp v23, v23, v29 quad_perm:[0,1,2,3] row_mask:0xf bank_mask:0xc
    v_sub_f32_dpp v18, v25, v18 row_ror:8 row_mask:0xf bank_mask:0xc
    v_sub_f32_dpp v22, v29, v22 row_ror:8 row_mask:0xf bank_mask:0xc
    v_add_f32_dpp v26, v17, v26 row_ror:8 row_mask:0xf bank_mask:0x3
    v_add_f32_dpp v30, v21, v30 row_ror:8 row_mask:0xf bank_mask:0x3
    v_cvt_pk_bf16_f32 v42, v16, v20
    v_cvt_pk_bf16_f32 v43, v24, v28
    v_cvt_pk_bf16_f32 v44, v26, v30
    v_cvt_pk_bf16_f32 v45, v19, v23
    v_cvt_pk_bf16_f32 v46, v18, v22
    v_cvt_pk_bf16_f32 v47, v17, v21
    ds_write_b32 v127, v42 offset:0
    ds_write_b32 v127, v43 offset:256
    ds_write_b32 v127, v44 offset:512
    ds_write_b32 v127, v45 offset:768
    ds_write_b32 v127, v46 offset:1024
    s_mov_b32 exec_lo, 0x00ff00ff
    s_mov_b32 exec_hi, 0x00ff00ff
    ds_write_b32 v127, v47 offset:1280
    s_mov_b64 exec, 1
    ds_add_u32 v54, v118
    s_mov_b64 exec, -1
G_EXT3D_pop:
    s_add_u32 s34, s34, 1
    s_cmp_eq_u32 s50, -1
    s_cbranch_scc1 G_DONE
    s_and_b32 s33, s50, 0xfffff
    s_lshr_b32 s32, s50, 20
    s_branch G_BODY0FD
G_DONE:
    s_cmp_lg_u32 s20, 0
    s_cbranch_scc1 K_FIN
    s_waitcnt vmcnt(0) lgkmcnt(0)
    s_setprio 0
    s_branch K_NEXT
K_M:
    s_sub_u32 s66, s16, 8
    v_and_b32 v8, 63, v0
    v_and_b32 v9, 15, v8
    v_lshrrev_b32 v10, 4, v8
    v_lshlrev_b32 v2, 4, v8
    s_mul_i32 s65, s66, 10240
    s_add_u32 s65, s65, 6422528
    s_waitcnt lgkmcnt(0)
    v_readfirstlane_b32 s48, v5
    s_cmp_eq_u32 s48, 0
    s_cbranch_scc1 M_START
    s_cmp_eq_u32 s17, 0
    s_cbranch_scc1 K_GOSLOW
M_START:
    s_setprio 0
    s_add_u32 s50, s65, 4096
    s_add_u32 s51, s65, 8192
    buffer_load_dwordx4 v[40:43], v2, s[8:11], s65 offen offset:0
    buffer_load_dwordx4 v[44:47], v2, s[8:11], s65 offen offset:1024
    buffer_load_dwordx4 v[48:51], v2, s[8:11], s65 offen offset:2048
    buffer_load_dwordx4 v[52:55], v2, s[8:11], s65 offen offset:3072
    buffer_load_dwordx4 v[56:59], v2, s[8:11], s50 offen offset:0
    buffer_load_dwordx4 v[60:63], v2, s[8:11], s50 offen offset:1024
    buffer_load_dwordx4 v[64:67], v2, s[8:11], s50 offen offset:2048
    buffer_load_dwordx4 v[68:71], v2, s[8:11], s50 offen offset:3072
    buffer_load_dwordx4 v[72:75], v2, s[8:11], s51 offen offset:0
    buffer_load_dwordx4 v[76:79], v2, s[8:11], s51 offen offset:1024
    s_setprio 0
    v_mul_u32_u24 v1, 1440, v9
    v_lshl_add_u32 v1, v10, 4, v1
    s_lshl_b32 s49, s66, 5
    v_mul_u32_u24 v4, 1040, v9
    v_lshl_add_u32 v4, v10, 3, v4
    v_add_u32 v4, s49, v4
    v_mov_b32 v36, 1
    s_mov_b32 s64, 0
    s_cmp_eq_u32 s27, 0
    s_cbranch_scc1 M_HLOOP
    v_mov_b32 v80, 0
    v_mov_b32 v81, 0
    v_mov_b32 v82, 0
    v_mov_b32 v83, 0
    v_mov_b32 v84, 0
    v_mov_b32 v85, 0
    v_mov_b32 v86, 0
    v_mov_b32 v87, 0
    v_mov_b32 v88, 0
    v_mov_b32 v89, 0
    v_mov_b32 v90, 0
    v_mov_b32 v91, 0
    v_mov_b32 v92, 0
    v_mov_b32 v93, 0
    v_mov_b32 v94, 0
    v_mov_b32 v95, 0
    v_mov_b32 v96, 0
    v_mov_b32 v97, 0
    v_mov_b32 v98, 0
    v_mov_b32 v99, 0
    v_mov_b32 v100, 0
    v_mov_b32 v101, 0
    v_mov_b32 v102, 0
    v_mov_b32 v103, 0
    v_mov_b32 v104, 0
    v_mov_b32 v105, 0
    v_mov_b32 v106, 0
    v_mov_b32 v107, 0
    v_mov_b32 v108, 0
    v_mov_b32 v109, 0
    v_mov_b32 v110, 0
    v_mov_b32 v111, 0
    v_mov_b32 v112, 0
    v_mov_b32 v113, 0
    v_mov_b32 v114, 0
    v_mov_b32 v115, 0
    v_mov_b32 v116, 0
    v_mov_b32 v117, 0
    v_mov_b32 v118, 0
    v_mov_b32 v119, 0
    v_mov_b32 v120, 0
    v_mov_b32 v121, 0
    v_mov_b32 v122, 0
    v_mov_b32 v123, 0
    v_mov_b32 v124, 0
    v_mov_b32 v125, 0
    v_mov_b32 v126, 0
    v_mov_b32 v127, 0
M_HLOOP:
    s_waitcnt vmcnt(0)
    s_mul_i32 s48, s64, 12
    s_add_u32 s48, s48, 146200
    v_mov_b32 v6, s48
    s_mov_b32 s50, 200000
M_POLL2:
    ds_read_b32 v7, v6
    s_waitcnt lgkmcnt(0)
    v_readfirstlane_b32 s49, v7
    s_sub_u32 s50, s50, 1
    s_cbranch_scc1 M_POLL2_go
    s_cmp_ge_u32 s49, 8
    s_cbranch_scc1 M_POLL2_go
    s_sleep 2
    s_branch M_POLL2
M_POLL2_go:
    s_mul_i32 s48, s64, 57600
    s_add_u32 s48, s48, 46080
    v_add_u32 v3, s48, v1
    ds_read_b128 v[16:19], v3 offset:1280
    ds_read_b128 v[20:23], v3 offset:1024
    ds_read_b128 v[24:27], v3 offset:768
    ds_read_b128 v[28:31], v3 offset:0
    s_waitcnt lgkmcnt(3)
    v_mfma_f32_16x16x32_bf16 v[116:119], v[56:59], v[16:19], v[116:119]
    ds_read_b128 v[32:35], v3 offset:1344
    s_waitcnt lgkmcnt(3)
    v_mfma_f32_16x16x32_bf16 v[120:123], v[56:59], v[20:23], v[120:123]
    ds_read_b128 v[16:19], v3 offset:1088
    s_waitcnt lgkmcnt(3)
    v_mfma_f32_16x16x32_bf16 v[124:127], v[56:59], v[24:27], v[124:127]
    ds_read_b128 v[20:23], v3 offset:832
    s_waitcnt lgkmcnt(3)
    v_mfma_f32_16x16x32_bf16 v[112:115], v[40:43], v[28:31], v[112:115]
    ds_read_b128 v[24:27], v3 offset:64
    s_waitcnt lgkmcnt(3)
    v_mfma_f32_16x16x32_bf16 v[116:119], v[60:63], v[32:35], v[116:119]
    ds_read_b128 v[28:31], v3 offset:192
    s_waitcnt lgkmcnt(3)
    v_mfma_f32_16x16x32_bf16 v[120:123], v[60:63], v[16:19], v[120:123]
    ds_read_b128 v[32:35], v3 offset:256
    s_waitcnt lgkmcnt(3)
    v_mfma_f32_16x16x32_bf16 v[124:127], v[60:63], v[20:23], v[124:127]
    ds_read_b128 v[16:19], v3 offset:448
    s_waitcnt lgkmcnt(3)
    v_mfma_f32_16x16x32_bf16 v[112:115], v[44:47], v[24:27], v[112:115]
    ds_read_b128 v[20:23], v3 offset:512
    s_waitcnt lgkmcnt(3)
    v_mfma_f32_16x16x32_bf16 v[116:119], v[64:67], v[28:31], v[116:119]
    ds_read_b128 v[24:27], v3 offset:128
    s_waitcnt lgkmcnt(3)
    v_mfma_f32_16x16x32_bf16 v[120:123], v[64:67], v[32:35], v[120:123]
    ds_read_b128 v[28:31], v3 offset:320
    s_waitcnt lgkmcnt(3)
    v_mfma_f32_16x16x32_bf16 v[124:127], v[64:67], v[16:19], v[124:127]
    ds_read_b128 v[32:35], v3 offset:384
    s_waitcnt lgkmcnt(3)
    v_mfma_f32_16x16x32_bf16 v[112:115], v[48:51], v[20:23], v[112:115]
    ds_read_b128 v[16:19], v3 offset:576
    s_waitcnt lgkmcnt(3)
    v_mfma_f32_16x16x32_bf16 v[116:119], v[68:71], v[24:27], v[116:119]
    ds_read_b128 v[20:23], v3 offset:704
    s_waitcnt lgkmcnt(3)
    v_mfma_f32_16x16x32_bf16 v[120:123], v[68:71], v[28:31], v[120:123]
    ds_read_b128 v[24:27], v3 offset:960
    s_waitcnt lgkmcnt(3)
    v_mfma_f32_16x16x32_bf16 v[124:127], v[68:71], v[32:35], v[124:127]
    ds_read_b128 v[28:31], v3 offset:1216
    s_waitcnt lgkmcnt(3)
    v_mfma_f32_16x16x32_bf16 v[112:115], v[52:55], v[16:19], v[112:115]
    ds_read_b128 v[32:35], v3 offset:640
    s_waitcnt lgkmcnt(3)
    v_mfma_f32_16x16x32_bf16 v[116:119], v[72:75], v[20:23], v[116:119]
    ds_read_b128 v[16:19], v3 offset:896
    s_waitcnt lgkmcnt(3)
    v_mfma_f32_16x16x32_bf16 v[120:123], v[72:75], v[24:27], v[120:123]
    ds_read_b128 v[20:23], v3 offset:1152
    s_waitcnt lgkmcnt(3)
    v_mfma_f32_16x16x32_bf16 v[124:127], v[72:75], v[28:31], v[124:127]
    s_waitcnt lgkmcnt(2)
    v_mfma_f32_16x16x32_bf16 v[116:119], v[76:79], v[32:35], v[116:119]
    s_waitcnt lgkmcnt(1)
    v_mfma_f32_16x16x32_bf16 v[120:123], v[76:79], v[16:19], v[120:123]
    s_waitcnt lgkmcnt(0)
    v_mfma_f32_16x16x32_bf16 v[124:127], v[76:79], v[20:23], v[124:127]
    s_cmp_eq_u32 s64, 0
    s_cbranch_scc1 M_NOFIN2
    s_cmp_eq_u32 s20, 0
    s_cbranch_scc1 M_NOFIN2
    s_mov_b32 s51, 0xbfb8aa3b
    s_nop 4
    v_mul_f32 v16, s51, v112
    v_mul_f32 v17, s51, v113
    v_mul_f32 v18, s51, v114
    v_mul_f32 v19, s51, v115
    v_exp_f32 v16, v16
    v_exp_f32 v17, v17
    v_exp_f32 v18, v18
    v_exp_f32 v19, v19
    v_cvt_pk_bf16_f32 v20, v112, v113
    v_cvt_pk_bf16_f32 v21, v114, v115
    v_add_f32 v16, 1.0, v16
    v_add_f32 v17, 1.0, v17
    v_add_f32 v18, 1.0, v18
    v_add_f32 v19, 1.0, v19
    v_rcp_f32 v16, v16
    v_rcp_f32 v17, v17
    v_rcp_f32 v18, v18
    v_rcp_f32 v19, v19
    v_mov_b32 v6, 146216
    s_mov_b32 s50, 200000
M_FIN0:
    ds_read_b32 v7, v6
    s_waitcnt lgkmcnt(0)
    v_readfirstlane_b32 s49, v7
    s_sub_u32 s50, s50, 1
    s_cbranch_scc1 M_FIN0_go
    s_cmp_ge_u32 s49, 8
    s_cbranch_scc1 M_FIN0_go
    s_sleep 1
    s_branch M_FIN0
M_FIN0_go:
    v_mul_f32 v116, v116, v16
    v_mul_f32 v117, v117, v17
    v_mul_f32 v118, v118, v18
    v_mul_f32 v119, v119, v19
    v_mul_f32 v120, v120, v16
    v_mul_f32 v121, v121, v17
    v_mul_f32 v122, v122, v18
    v_mul_f32 v123, v123, v19
    v_mul_f32 v124, v124, v16
    v_mul_f32 v125, v125, v17
    v_mul_f32 v126, v126, v18
    v_mul_f32 v127, v127, v19
    v_cvt_pk_bf16_f32 v22, v116, v117
    v_cvt_pk_bf16_f32 v23, v118, v119
    v_cvt_pk_bf16_f32 v24, v120, v121
    v_cvt_pk_bf16_f32 v25, v122, v123
    v_cvt_pk_bf16_f32 v26, v124, v125
    v_cvt_pk_bf16_f32 v27, v126, v127
    s_mov_b32 exec_lo, 0x00ff00ff
    s_mov_b32 exec_hi, 0x00ff00ff
    ds_write_b64 v4, v[20:21] offset:46080
    ds_write_b64 v4, v[22:23] offset:46336
    ds_write_b64 v4, v[24:25] offset:46592
    ds_write_b64 v4, v[26:27] offset:46848
    v_mov_b32 v6, 146228
    s_mov_b64 exec, 1
    ds_add_u32 v6, v36
    s_mov_b64 exec, -1
    s_mul_i32 s48, s66, 1040
    s_add_u32 s48, s48, 46080
    v_add_u32 v3, s48, v2
    s_mul_i32 s51, s66, 1
    s_add_u32 s51, s51, 32
    s_mov_b32 s52, s51
    s_add_u32 s51, s51, s21
    s_lshl_b32 s51, s51, 10
    v_mov_b32 v6, 146228
    s_mov_b32 s50, 200000
M_WR2:
    ds_read_b32 v7, v6
    s_waitcnt lgkmcnt(0)
    v_readfirstlane_b32 s49, v7
    s_sub_u32 s50, s50, 1
    s_cbranch_scc1 M_WR2_go
    s_cmp_ge_u32 s49, 8
    s_cbranch_scc1 M_WR2_go
    s_branch M_WR2
M_WR2_go:
    s_cmp_ge_u32 s52, s23
    s_cbranch_scc1 M_NOFIN2
    ds_read_b128 v[28:31], v3 offset:0
    s_waitcnt lgkmcnt(0)
    buffer_store_dwordx4 v[28:31], v2, s[12:15], s51 offen offset:0 sc0 sc1 nt
M_NOFIN2:
    s_mul_i32 s48, s64, 12
    s_add_u32 s48, s48, 146192
    v_mov_b32 v6, s48
    s_mov_b32 s50, 200000
M_POLL0:
    ds_read_b32 v7, v6
    s_waitcnt lgkmcnt(0)
    v_readfirstlane_b32 s49, v7
    s_sub_u32 s50, s50, 1
    s_cbranch_scc1 M_POLL0_go
    s_cmp_ge_u32 s49, 16
    s_cbranch_scc1 M_POLL0_go
    s_sleep 2
    s_branch M_POLL0
M_POLL0_go:
    s_mul_i32 s48, s64, 57600
    s_add_u32 s48, s48, 0
    v_add_u32 v3, s48, v1
    ds_read_b128 v[16:19], v3 offset:1280
    ds_read_b128 v[20:23], v3 offset:1024
    ds_read_b128 v[24:27], v3 offset:768
    ds_read_b128 v[28:31], v3 offset:0
    s_waitcnt lgkmcnt(3)
    v_mfma_f32_16x16x32_bf16 v[84:87], v[56:59], v[16:19], v[84:87]
    ds_read_b128 v[32:35], v3 offset:1344
    s_waitcnt lgkmcnt(3)
    v_mfma_f32_16x16x32_bf16 v[88:91], v[56:59], v[20:23], v[88:91]
    ds_read_b128 v[16:19], v3 offset:1088
    s_waitcnt lgkmcnt(3)
    v_mfma_f32_16x16x32_bf16 v[92:95], v[56:59], v[24:27], v[92:95]
    ds_read_b128 v[20:23], v3 offset:832
    s_waitcnt lgkmcnt(3)
    v_mfma_f32_16x16x32_bf16 v[80:83], v[40:43], v[28:31], v[80:83]
    ds_read_b128 v[24:27], v3 offset:64
    s_waitcnt lgkmcnt(3)
    v_mfma_f32_16x16x32_bf16 v[84:87], v[60:63], v[32:35], v[84:87]
    ds_read_b128 v[28:31], v3 offset:192
    s_waitcnt lgkmcnt(3)
    v_mfma_f32_16x16x32_bf16 v[88:91], v[60:63], v[16:19], v[88:91]
    ds_read_b128 v[32:35], v3 offset:256
    s_waitcnt lgkmcnt(3)
    v_mfma_f32_16x16x32_bf16 v[92:95], v[60:63], v[20:23], v[92:95]
    ds_read_b128 v[16:19], v3 offset:448
    s_waitcnt lgkmcnt(3)
    v_mfma_f32_16x16x32_bf16 v[80:83], v[44:47], v[24:27], v[80:83]
    ds_read_b128 v[20:23], v3 offset:512
    s_waitcnt lgkmcnt(3)
    v_mfma_f32_16x16x32_bf16 v[84:87], v[64:67], v[28:31], v[84:87]
    ds_read_b128 v[24:27], v3 offset:128
    s_waitcnt lgkmcnt(3)
    v_mfma_f32_16x16x32_bf16 v[88:91], v[64:67], v[32:35], v[88:91]
    ds_read_b128 v[28:31], v3 offset:320
    s_waitcnt lgkmcnt(3)
    v_mfma_f32_16x16x32_bf16 v[92:95], v[64:67], v[16:19], v[92:95]
    ds_read_b128 v[32:35], v3 offset:384
    s_waitcnt lgkmcnt(3)
    v_mfma_f32_16x16x32_bf16 v[80:83], v[48:51], v[20:23], v[80:83]
    ds_read_b128 v[16:19], v3 offset:576
    s_waitcnt lgkmcnt(3)
    v_mfma_f32_16x16x32_bf16 v[84:87], v[68:71], v[24:27], v[84:87]
    ds_read_b128 v[20:23], v3 offset:704
    s_waitcnt lgkmcnt(3)
    v_mfma_f32_16x16x32_bf16 v[88:91], v[68:71], v[28:31], v[88:91]
    ds_read_b128 v[24:27], v3 offset:960
    s_waitcnt lgkmcnt(3)
    v_mfma_f32_16x16x32_bf16 v[92:95], v[68:71], v[32:35], v[92:95]
    ds_read_b128 v[28:31], v3 offset:1216
    s_waitcnt lgkmcnt(3)
    v_mfma_f32_16x16x32_bf16 v[80:83], v[52:55], v[16:19], v[80:83]
    ds_read_b128 v[32:35], v3 offset:640
    s_waitcnt lgkmcnt(3)
    v_mfma_f32_16x16x32_bf16 v[84:87], v[72:75], v[20:23], v[84:87]
    ds_read_b128 v[16:19], v3 offset:896
    s_waitcnt lgkmcnt(3)
    v_mfma_f32_16x16x32_bf16 v[88:91], v[72:75], v[24:27], v[88:91]
    ds_read_b128 v[20:23], v3 offset:1152
    s_waitcnt lgkmcnt(3)
    v_mfma_f32_16x16x32_bf16 v[92:95], v[72:75], v[28:31], v[92:95]
    s_waitcnt lgkmcnt(2)
    v_mfma_f32_16x16x32_bf16 v[84:87], v[76:79], v[32:35], v[84:87]
    s_waitcnt lgkmcnt(1)
    v_mfma_f32_16x16x32_bf16 v[88:91], v[76:79], v[16:19], v[88:91]
    s_waitcnt lgkmcnt(0)
    v_mfma_f32_16x16x32_bf16 v[92:95], v[76:79], v[20:23], v[92:95]
    s_cmp_eq_u32 s64, 0
    s_cbranch_scc1 M_NOFIN0
    s_cmp_eq_u32 s20, 0
    s_cbranch_scc1 M_NOFIN0
    s_mov_b32 s51, 0xbfb8aa3b
    s_nop 4
    v_mul_f32 v16, s51, v80
    v_mul_f32 v17, s51, v81
    v_mul_f32 v18, s51, v82
    v_mul_f32 v19, s51, v83
    v_exp_f32 v16, v16
    v_exp_f32 v17, v17
    v_exp_f32 v18, v18
    v_exp_f32 v19, v19
    v_cvt_pk_bf16_f32 v20, v80, v81
    v_cvt_pk_bf16_f32 v21, v82, v83
    v_add_f32 v16, 1.0, v16
    v_add_f32 v17, 1.0, v17
    v_add_f32 v18, 1.0, v18
    v_add_f32 v19, 1.0, v19
    v_rcp_f32 v16, v16
    v_rcp_f32 v17, v17
    v_rcp_f32 v18, v18
    v_rcp_f32 v19, v19
    v_mul_f32 v84, v84, v16
    v_mul_f32 v85, v85, v17
    v_mul_f32 v86, v86, v18
    v_mul_f32 v87, v87, v19
    v_mul_f32 v88, v88, v16
    v_mul_f32 v89, v89, v17
    v_mul_f32 v90, v90, v18
    v_mul_f32 v91, v91, v19
    v_mul_f32 v92, v92, v16
    v_mul_f32 v93, v93, v17
    v_mul_f32 v94, v94, v18
    v_mul_f32 v95, v95, v19
    v_cvt_pk_bf16_f32 v22, v84, v85
    v_cvt_pk_bf16_f32 v23, v86, v87
    v_cvt_pk_bf16_f32 v24, v88, v89
    v_cvt_pk_bf16_f32 v25, v90, v91
    v_cvt_pk_bf16_f32 v26, v92, v93
    v_cvt_pk_bf16_f32 v27, v94, v95
    ds_write_b64 v4, v[20:21] offset:0
    ds_write_b64 v4, v[22:23] offset:256
    ds_write_b64 v4, v[24:25] offset:512
    ds_write_b64 v4, v[26:27] offset:768
    v_mov_b32 v6, 146220
    s_mov_b64 exec, 1
    ds_add_u32 v6, v36
    s_mov_b64 exec, -1
    s_mul_i32 s48, s66, 2080
    s_add_u32 s48, s48, 0
    v_add_u32 v3, s48, v2
    s_mul_i32 s51, s66, 2
    s_add_u32 s51, s51, 0
    s_add_u32 s51, s51, s21
    s_lshl_b32 s51, s51, 10
    v_mov_b32 v6, 146220
    s_mov_b32 s50, 200000
M_WR0:
    ds_read_b32 v7, v6
    s_waitcnt lgkmcnt(0)
    v_readfirstlane_b32 s49, v7
    s_sub_u32 s50, s50, 1
    s_cbranch_scc1 M_WR0_go
    s_cmp_ge_u32 s49, 8
    s_cbranch_scc1 M_WR0_go
    s_branch M_WR0
M_WR0_go:
    ds_read_b128 v[28:31], v3 offset:0
    ds_read_b128 v[32:35], v3 offset:1040
    s_waitcnt lgkmcnt(1)
    buffer_store_dwordx4 v[28:31], v2, s[12:15], s51 offen offset:0 sc0 sc1 nt
    s_waitcnt lgkmcnt(0)
    buffer_store_dwordx4 v[32:35], v2, s[12:15], s51 offen offset:1024 sc0 sc1 nt
M_NOFIN0:
    s_mul_i32 s48, s64, 12
    s_add_u32 s48, s48, 146196
    v_mov_b32 v6, s48
    s_mov_b32 s50, 200000
M_POLL1:
    ds_read_b32 v7, v6
    s_waitcnt lgkmcnt(0)
    v_readfirstlane_b32 s49, v7
    s_sub_u32 s50, s50, 1
    s_cbranch_scc1 M_POLL1_go
    s_cmp_ge_u32 s49, 16
    s_cbranch_scc1 M_POLL1_go
    s_sleep 2
    s_branch M_POLL1
M_POLL1_go:
    s_mul_i32 s48, s64, 57600
    s_add_u32 s48, s48, 23040
    v_add_u32 v3, s48, v1
    ds_read_b128 v[16:19], v3 offset:1280
    ds_read_b128 v[20:23], v3 offset:1024
    ds_read_b128 v[24:27], v3 offset:768
    ds_read_b128 v[28:31], v3 offset:0
    s_add_u32 s52, s65, 81920
    s_add_u32 s53, s52, 4096
    s_add_u32 s54, s52, 8192
    s_cmp_eq_u32 s64, 0
    s_cbranch_scc0 M_PLAIN1
    s_setprio 3
    s_waitcnt lgkmcnt(3)
    v_mfma_f32_16x16x32_bf16 v[100:103], v[56:59], v[16:19], v[100:103]
    ds_read_b128 v[32:35], v3 offset:1344
    s_waitcnt lgkmcnt(3)
    v_mfma_f32_16x16x32_bf16 v[104:107], v[56:59], v[20:23], v[104:107]
    ds_read_b128 v[16:19], v3 offset:1088
    s_waitcnt lgkmcnt(3)
    v_mfma_f32_16x16x32_bf16 v[108:111], v[56:59], v[24:27], v[108:111]
    ds_read_b128 v[20:23], v3 offset:832
    s_waitcnt lgkmcnt(3)
    v_mfma_f32_16x16x32_bf16 v[96:99], v[40:43], v[28:31], v[96:99]
    ds_read_b128 v[24:27], v3 offset:64
    buffer_load_dwordx4 v[56:59], v2, s[8:11], s53 offen offset:0
    s_waitcnt lgkmcnt(3)
    v_mfma_f32_16x16x32_bf16 v[100:103], v[60:63], v[32:35], v[100:103]
    ds_read_b128 v[28:31], v3 offset:192
    buffer_load_dwordx4 v[40:43], v2, s[8:11], s52 offen offset:0
    s_waitcnt lgkmcnt(3)
    v_mfma_f32_16x16x32_bf16 v[104:107], v[60:63], v[16:19], v[104:107]
    ds_read_b128 v[32:35], v3 offset:256
    s_waitcnt lgkmcnt(3)
    v_mfma_f32_16x16x32_bf16 v[108:111], v[60:63], v[20:23], v[108:111]
    ds_read_b128 v[16:19], v3 offset:448
    s_waitcnt lgkmcnt(3)
    v_mfma_f32_16x16x32_bf16 v[96:99], v[44:47], v[24:27], v[96:99]
    ds_read_b128 v[20:23], v3 offset:512
    buffer_load_dwordx4 v[60:63], v2, s[8:11], s53 offen offset:1024
    s_waitcnt lgkmcnt(3)
    v_mfma_f32_16x16x32_bf16 v[100:103], v[64:67], v[28:31], v[100:103]
    ds_read_b128 v[24:27], v3 offset:128
    buffer_load_dwordx4 v[44:47], v2, s[8:11], s52 offen offset:1024
    s_waitcnt lgkmcnt(3)
    v_mfma_f32_16x16x32_bf16 v[104:107], v[64:67], v[32:35], v[104:107]
    ds_read_b128 v[28:31], v3 offset:320
    s_waitcnt lgkmcnt(3)
    v_mfma_f32_16x16x32_bf16 v[108:111], v[64:67], v[16:19], v[108:111]
    ds_read_b128 v[32:35], v3 offset:384
    s_waitcnt lgkmcnt(3)
    v_mfma_f32_16x16x32_bf16 v[96:99], v[48:51], v[20:23], v[96:99]
    ds_read_b128 v[16:19], v3 offset:576
    buffer_load_dwordx4 v[64:67], v2, s[8:11], s53 offen offset:2048
    s_waitcnt lgkmcnt(3)
    v_mfma_f32_16x16x32_bf16 v[100:103], v[68:71], v[24:27], v[100:103]
    ds_read_b128 v[20:23], v3 offset:704
    buffer_load_dwordx4 v[48:51], v2, s[8:11], s52 offen offset:2048
    s_waitcnt lgkmcnt(3)
    v_mfma_f32_16x16x32_bf16 v[104:107], v[68:71], v[28:31], v[104:107]
    ds_read_b128 v[24:27], v3 offset:960
    s_waitcnt lgkmcnt(3)
    v_mfma_f32_16x16x32_bf16 v[108:111], v[68:71], v[32:35], v[108:111]
    ds_read_b128 v[28:31], v3 offset:1216
    s_waitcnt lgkmcnt(3)
    v_mfma_f32_16x16x32_bf16 v[96:99], v[52:55], v[16:19], v[96:99]
    ds_read_b128 v[32:35], v3 offset:640
    buffer_load_dwordx4 v[68:71], v2, s[8:11], s53 offen offset:3072
    s_waitcnt lgkmcnt(3)
    v_mfma_f32_16x16x32_bf16 v[100:103], v[72:75], v[20:23], v[100:103]
    ds_read_b128 v[16:19], v3 offset:896
    buffer_load_dwordx4 v[52:55], v2, s[8:11], s52 offen offset:3072
    s_waitcnt lgkmcnt(3)
    v_mfma_f32_16x16x32_bf16 v[104:107], v[72:75], v[24:27], v[104:107]
    ds_read_b128 v[20:23], v3 offset:1152
    s_waitcnt lgkmcnt(3)
    v_mfma_f32_16x16x32_bf16 v[108:111], v[72:75], v[28:31], v[108:111]
    s_waitcnt lgkmcnt(2)
    v_mfma_f32_16x16x32_bf16 v[100:103], v[76:79], v[32:35], v[100:103]
    buffer_load_dwordx4 v[72:75], v2, s[8:11], s54 offen offset:0
    s_waitcnt lgkmcnt(1)
    v_mfma_f32_16x16x32_bf16 v[104:107], v[76:79], v[16:19], v[104:107]
    s_waitcnt lgkmcnt(0)
    v_mfma_f32_16x16x32_bf16 v[108:111], v[76:79], v[20:23], v[108:111]
    buffer_load_dwordx4 v[76:79], v2, s[8:11], s54 offen offset:1024
    s_setprio 0
    v_mov_b32 v6, 146216
    s_mov_b64 exec, 1
    ds_add_u32 v6, v36
    s_mov_b64 exec, -1
    s_branch M_NOFIN1
M_PLAIN1:
    s_waitcnt lgkmcnt(3)
    v_mfma_f32_16x16x32_bf16 v[100:103], v[56:59], v[16:19], v[100:103]
    ds_read_b128 v[32:35], v3 offset:1344
    s_waitcnt lgkmcnt(3)
    v_mfma_f32_16x16x32_bf16 v[104:107], v[56:59], v[20:23], v[104:107]
    ds_read_b128 v[16:19], v3 offset:1088
    s_waitcnt lgkmcnt(3)
    v_mfma_f32_16x16x32_bf16 v[108:111], v[56:59], v[24:27], v[108:111]
    ds_read_b128 v[20:23], v3 offset:832
    s_waitcnt lgkmcnt(3)
    v_mfma_f32_16x16x32_bf16 v[96:99], v[40:43], v[28:31], v[96:99]
    ds_read_b128 v[24:27], v3 offset:64
    s_waitcnt lgkmcnt(3)
    v_mfma_f32_16x16x32_bf16 v[100:103], v[60:63], v[32:35], v[100:103]
    ds_read_b128 v[28:31], v3 offset:192
    s_waitcnt lgkmcnt(3)
    v_mfma_f32_16x16x32_bf16 v[104:107], v[60:63], v[16:19], v[104:107]
    ds_read_b128 v[32:35], v3 offset:256
    s_waitcnt lgkmcnt(3)
    v_mfma_f32_16x16x32_bf16 v[108:111], v[60:63], v[20:23], v[108:111]
    ds_read_b128 v[16:19], v3 offset:448
    s_waitcnt lgkmcnt(3)
    v_mfma_f32_16x16x32_bf16 v[96:99], v[44:47], v[24:27], v[96:99]
    ds_read_b128 v[20:23], v3 offset:512
    s_waitcnt lgkmcnt(3)
    v_mfma_f32_16x16x32_bf16 v[100:103], v[64:67], v[28:31], v[100:103]
    ds_read_b128 v[24:27], v3 offset:128
    s_waitcnt lgkmcnt(3)
    v_mfma_f32_16x16x32_bf16 v[104:107], v[64:67], v[32:35], v[104:107]
    ds_read_b128 v[28:31], v3 offset:320
    s_waitcnt lgkmcnt(3)
    v_mfma_f32_16x16x32_bf16 v[108:111], v[64:67], v[16:19], v[108:111]
    ds_read_b128 v[32:35], v3 offset:384
    s_waitcnt lgkmcnt(3)
    v_mfma_f32_16x16x32_bf16 v[96:99], v[48:51], v[20:23], v[96:99]
    ds_read_b128 v[16:19], v3 offset:576
    s_waitcnt lgkmcnt(3)
    v_mfma_f32_16x16x32_bf16 v[100:103], v[68:71], v[24:27], v[100:103]
    ds_read_b128 v[20:23], v3 offset:704
    s_waitcnt lgkmcnt(3)
    v_mfma_f32_16x16x32_bf16 v[104:107], v[68:71], v[28:31], v[104:107]
    ds_read_b128 v[24:27], v3 offset:960
    s_waitcnt lgkmcnt(3)
    v_mfma_f32_16x16x32_bf16 v[108:111], v[68:71], v[32:35], v[108:111]
    ds_read_b128 v[28:31], v3 offset:1216
    s_waitcnt lgkmcnt(3)
    v_mfma_f32_16x16x32_bf16 v[96:99], v[52:55], v[16:19], v[96:99]
    ds_read_b128 v[32:35], v3 offset:640
    s_waitcnt lgkmcnt(3)
    v_mfma_f32_16x16x32_bf16 v[100:103], v[72:75], v[20:23], v[100:103]
    ds_read_b128 v[16:19], v3 offset:896
    s_waitcnt lgkmcnt(3)
    v_mfma_f32_16x16x32_bf16 v[104:107], v[72:75], v[24:27], v[104:107]
    ds_read_b128 v[20:23], v3 offset:1152
    s_waitcnt lgkmcnt(3)
    v_mfma_f32_16x16x32_bf16 v[108:111], v[72:75], v[28:31], v[108:111]
    s_waitcnt lgkmcnt(2)
    v_mfma_f32_16x16x32_bf16 v[100:103], v[76:79], v[32:35], v[100:103]
    s_waitcnt lgkmcnt(1)
    v_mfma_f32_16x16x32_bf16 v[104:107], v[76:79], v[16:19], v[104:107]
    s_waitcnt lgkmcnt(0)
    v_mfma_f32_16x16x32_bf16 v[108:111], v[76:79], v[20:23], v[108:111]
    s_cmp_eq_u32 s64, 0
    s_cbranch_scc1 M_NOFIN1
    s_cmp_eq_u32 s20, 0
    s_cbranch_scc1 M_NOFIN1
    s_mov_b32 s51, 0xbfb8aa3b
    s_nop 4
    v_mul_f32 v16, s51, v96
    v_mul_f32 v17, s51, v97
    v_mul_f32 v18, s51, v98
    v_mul_f32 v19, s51, v99
    v_exp_f32 v16, v16
    v_exp_f32 v17, v17
    v_exp_f32 v18, v18
    v_exp_f32 v19, v19
    v_cvt_pk_bf16_f32 v20, v96, v97
    v_cvt_pk_bf16_f32 v21, v98, v99
    v_add_f32 v16, 1.0, v16
    v_add_f32 v17, 1.0, v17
    v_add_f32 v18, 1.0, v18
    v_add_f32 v19, 1.0, v19
    v_rcp_f32 v16, v16
    v_rcp_f32 v17, v17
    v_rcp_f32 v18, v18
    v_rcp_f32 v19, v19
    v_mul_f32 v100, v100, v16
    v_mul_f32 v101, v101, v17
    v_mul_f32 v102, v102, v18
    v_mul_f32 v103, v103, v19
    v_mul_f32 v104, v104, v16
    v_mul_f32 v105, v105, v17
    v_mul_f32 v106, v106, v18
    v_mul_f32 v107, v107, v19
    v_mul_f32 v108, v108, v16
    v_mul_f32 v109, v109, v17
    v_mul_f32 v110, v110, v18
    v_mul_f32 v111, v111, v19
    v_cvt_pk_bf16_f32 v22, v100, v101
    v_cvt_pk_bf16_f32 v23, v102, v103
    v_cvt_pk_bf16_f32 v24, v104, v105
    v_cvt_pk_bf16_f32 v25, v106, v107
    v_cvt_pk_bf16_f32 v26, v108, v109
    v_cvt_pk_bf16_f32 v27, v110, v111
    ds_write_b64 v4, v[20:21] offset:23040
    ds_write_b64 v4, v[22:23] offset:23296
    ds_write_b64 v4, v[24:25] offset:23552
    ds_write_b64 v4, v[26:27] offset:23808
    v_mov_b32 v6, 146224
    s_mov_b64 exec, 1
    ds_add_u32 v6, v36
    s_mov_b64 exec, -1
    s_mul_i32 s48, s66, 2080
    s_add_u32 s48, s48, 23040
    v_add_u32 v3, s48, v2
    s_mul_i32 s51, s66, 2
    s_add_u32 s51, s51, 16
    s_add_u32 s51, s51, s21
    s_lshl_b32 s51, s51, 10
    v_mov_b32 v6, 146224
    s_mov_b32 s50, 200000
M_WR1:
    ds_read_b32 v7, v6
    s_waitcnt lgkmcnt(0)
    v_readfirstlane_b32 s49, v7
    s_sub_u32 s50, s50, 1
    s_cbranch_scc1 M_WR1_go
    s_cmp_ge_u32 s49, 8
    s_cbranch_scc1 M_WR1_go
    s_branch M_WR1
M_WR1_go:
    ds_read_b128 v[28:31], v3 offset:0
    ds_read_b128 v[32:35], v3 offset:1040
    s_waitcnt lgkmcnt(1)
    buffer_store_dwordx4 v[28:31], v2, s[12:15], s51 offen offset:0 sc0 sc1 nt
    s_waitcnt lgkmcnt(0)
    buffer_store_dwordx4 v[32:35], v2, s[12:15], s51 offen offset:1024 sc0 sc1 nt
M_NOFIN1:
    s_cmp_lg_u32 s64, 0
    s_cbranch_scc1 M_DONE
    s_mov_b32 s64, 1
    s_branch M_HLOOP
M_DONE:
    s_cmp_lg_u32 s20, 0
    s_cbranch_scc1 K_FIN
    s_waitcnt vmcnt(0) lgkmcnt(0)
K_NEXT:
    s_barrier
    s_mov_b32 s27, 0
    s_cmp_eq_u32 s17, 1
    s_cbranch_scc0 K_NEXT_B
    s_add_u32 s18, s18, 1
    s_cmp_lt_u32 s18, 64
    s_cbranch_scc1 K_BATCH
    s_mov_b32 s17, 2
    s_mov_b32 s18, 0
    s_mov_b32 s19, 0
    s_branch K_NEXT_CHK
K_NEXT_B:
    s_add_u32 s19, s19, 1
K_NEXT_CHK:
    s_cmp_ge_u32 s18, 64
    s_cbranch_scc1 K_NEXT_END
    s_and_b32 s48, s2, 0xc0
    s_add_u32 s48, s48, s18
    s_lshl_b32 s48, s48, 2
    s_add_u32 s48, s48, 6291456
    s_add_u32 s50, s8, s48
    s_addc_u32 s51, s9, 0
    s_load_dword s22, s[50:51], 0
    s_waitcnt lgkmcnt(0)
    s_lshl_b32 s48, s19, 5
    s_cmp_lt_u32 s48, s22
    s_cbranch_scc1 K_BATCH
    s_add_u32 s18, s18, 1
    s_mov_b32 s19, 0
    s_branch K_NEXT_CHK
K_NEXT_END:
    s_mov_b32 s17, 3
    s_mov_b32 s20, 1
    s_branch K_BATCH
K_GOSLOW:
    s_mov_b32 s17, 1
    s_mov_b32 s18, 0
    s_mov_b32 s20, 0
    s_setprio 0
    s_waitcnt vmcnt(0) lgkmcnt(0)
    s_barrier
    s_branch K_BATCH
K_FIN:
K_END:
    s_endpgm
.section .rodata,"a"
.p2align 6
.amdhsa_kernel gs_prep_kernel
.amdhsa_next_free_vgpr 80
.amdhsa_next_free_sgpr 64
.amdhsa_accum_offset 80
.amdhsa_group_segment_fixed_size 0
.amdhsa_kernarg_size 96
.amdhsa_user_sgpr_count 2
.amdhsa_user_sgpr_kernarg_segment_ptr 1
.amdhsa_system_sgpr_workgroup_id_x 1
.amdhsa_float_denorm_mode_32 3
.end_amdhsa_kernel
.p2align 6
.amdhsa_kernel gather_scatter__tensor_product_equiv_equiformer__graph_kernel
.amdhsa_next_free_vgpr 128
.amdhsa_next_free_sgpr 80
.amdhsa_accum_offset 128
.amdhsa_group_segment_fixed_size 0
.amdhsa_kernarg_size 96
.amdhsa_user_sgpr_count 2
.amdhsa_user_sgpr_kernarg_segment_ptr 1
.amdhsa_system_sgpr_workgroup_id_x 1
.amdhsa_float_denorm_mode_32 3
.end_amdhsa_kernel
```
